```python
import torch

def _softmax(x, axis=-1):
    return torch.softmax(x, dim=axis)

def _gelu(x):
    return torch.nn.functional.gelu(x, approximate='tanh')

def _silu(x):
    return torch.nn.functional.silu(x)

def _sigmoid(x):
    return torch.sigmoid(x)

def _layernorm(x, axis=-1, eps=1e-05):
    m = x.mean(dim=axis, keepdim=True)
    v = x.var(dim=axis, keepdim=True, unbiased=False)
    return (x - m) / torch.sqrt(v + eps)

def _scatter_add(tgt, idx, src, axis=0):
    return tgt.clone().index_add_(axis, idx, src)

def _segment_sum(src, seg, n):
    out = torch.zeros((n,) + src.shape[1:], dtype=src.dtype)
    return out.index_add_(0, seg, src)

def _pad(x, pw):
    flat = tuple((v for pair in reversed(pw) for v in pair))
    return torch.nn.functional.pad(x, flat)
kernel_name = 'adaLN_cond__gqa_block_cached__swiglu_ffn__decode'

def setup_inputs():

    _w = lambda a: (lambda t: t.to(torch.bfloat16) if t.is_floating_point() else t)(torch.as_tensor(a))

    def _A_setup():
        B, Sq, D = (1, 1, 512)
        Hq, Hkv, Sk, Dh = (32, 8, 65536, 128)
        assert Hq % Hkv == 0, (Hq, Hkv)
        return {'x': _w((lambda *s: torch.randn(*s, dtype=torch.bfloat16) * 0.05)(B, Sq, D)), 'k_cache': _w((lambda *s: torch.randn(*s, dtype=torch.bfloat16) * 3.2)(B, Hkv, Sk, Dh)), 'v_cache': _w((lambda *s: torch.randn(*s, dtype=torch.bfloat16) * 0.4)(B, Hkv, Sk, Dh)), 'wq': _w((lambda *s: torch.randn(*s, dtype=torch.bfloat16) * 3.2)(D, Hq * Dh) * D ** (-0.5)), 'wo': _w((lambda *s: torch.randn(*s, dtype=torch.bfloat16) * 0.4)(Hq * Dh, D) * (Hq * Dh) ** (-0.5))}
    _A_in = _A_setup()

    def _B_setup():
        B, S, D, F = (1, 1, 512, 1792)
        return {'x': _w((lambda *s: torch.randn(*s, dtype=torch.bfloat16) * 0.05)(B, S, D)), 'w_gate': _w((lambda *s: torch.randn(*s, dtype=torch.bfloat16) * 0.05)(D, F)), 'w_up': _w((lambda *s: torch.randn(*s, dtype=torch.bfloat16) * 0.05)(D, F)), 'w_down': _w((lambda *s: torch.randn(*s, dtype=torch.bfloat16) * 0.05)(F, D))}
    _B_in = _B_setup()
    return {'A_x': _A_in['x'], 'A_k_cache': _A_in['k_cache'], 'A_v_cache': _A_in['v_cache'], 'A_wq': _A_in['wq'], 'A_wo': _A_in['wo'], 'B_x': _B_in['x'], 'B_w_gate': _B_in['w_gate'], 'B_w_up': _B_in['w_up'], 'B_w_down': _B_in['w_down'], 'c': _w((lambda *s: torch.randn(*s, dtype=torch.bfloat16) * 0.2)(1, 512) * 8.0), 'w_mod': _w((lambda *s: torch.randn(*s, dtype=torch.bfloat16) * 0.2)(512, 6 * 512) * 512 ** (-0.5) * 8.0)}

def reference(A_x, A_k_cache, A_v_cache, A_wq, A_wo, B_x, B_w_gate, B_w_up, B_w_down, c, w_mod):

    def _A_ref(x, k_cache, v_cache, wq, wo):
        B, Sq, D = x.shape
        Hq, Dh = (32, 128)
        Hkv = k_cache.shape[1]
        rep = Hq // Hkv
        q = (lambda x, *d: x.permute(*d))((x @ wq).reshape(B, Sq, Hq, Dh), 0, 2, 1, 3)
        k = (lambda x, n, axis: torch.repeat_interleave(x, n, dim=axis))(k_cache, rep, axis=1)
        v = (lambda x, n, axis: torch.repeat_interleave(x, n, dim=axis))(v_cache, rep, axis=1)
        scores = torch.einsum('bhqd,bhkd->bhqk', q, k) * Dh ** (-0.5)
        p = _softmax(scores, axis=-1)
        o = torch.einsum('bhqk,bhkd->bhqd', p, v)
        return (lambda x, *d: x.permute(*d))(o, 0, 2, 1, 3).reshape(B, Sq, Hq * Dh) @ wo

    def _B_ref(x, w_gate, w_up, w_down):
        g = _silu(x @ w_gate)
        u = x @ w_up
        return g * u @ w_down
    x = A_x
    mod = (_silu(c) @ w_mod).reshape(c.shape[0], 6, 1, -1)
    sa, ca, ga, sb, cb, gb = (mod[:, 0].clone(), mod[:, 1].clone(), mod[:, 2].clone(), mod[:, 3].clone(), mod[:, 4].clone(), mod[:, 5].clone())
    h = _layernorm(x, axis=-1) * (1 + ca) + sa
    x = x + ga * _A_ref(h, A_k_cache, A_v_cache, A_wq, A_wo)
    h = _layernorm(x, axis=-1) * (1 + cb) + sb
    x = x + gb * _B_ref(h, B_w_gate, B_w_up, B_w_down)
    return x
```

```asm
; @launch grid=(256,1,1) block=(512,1,1) lds=86016
.amdgcn_target "amdgcn-amd-amdhsa--gfx950"
.text
.globl adaLN_cond__gqa_block_cached__swiglu_ffn__decode_kernel
.p2align 8
.type adaLN_cond__gqa_block_cached__swiglu_ffn__decode_kernel,@function
adaLN_cond__gqa_block_cached__swiglu_ffn__decode_kernel:
  s_cmp_ge_u32 s2, 256
  s_cbranch_scc1 L_end
  s_load_dwordx16 s[4:19], s[0:1], 0
  s_load_dwordx8 s[20:27], s[0:1], 64
  s_load_dwordx4 s[28:31], s[0:1], 96
  v_lshrrev_b32 v2, 6, v0
  v_and_b32 v1, 63, v0
  v_readfirstlane_b32 s52, v2
  v_lshrrev_b32 v2, 4, v1
  v_and_b32 v3, 15, v1
  s_lshr_b32 s53, s2, 3
  s_and_b32 s3, s2, 7
  s_cmp_ge_u32 s52, 4
  s_cbranch_scc1 L_stream
L_T1:
  s_getpc_b64 s[66:67]
L_pc:
  v_lshlrev_b32 v4, 9, v1
  s_lshl_b32 s68, s52, 7
  v_add_u32 v4, s68, v4
  v_cmp_gt_u32 vcc, L_last-L_pc, v4
  s_mov_b64 exec, vcc
  global_load_dword v31, v4, s[66:67]
  s_mov_b64 exec, -1
  v_mov_b32 v16, 0
  v_mov_b32 v17, 0
  v_mov_b32 v18, 0
  v_mov_b32 v19, 0
  ds_write_b128 v16, v[16:19] offset:1280
  ds_write_b32 v16, v16 offset:1296
  s_mov_b32 s47, 0x20000
  s_mov_b32 s51, 0x20000
  s_mov_b32 s50, 1024
  s_lshl_b32 s66, s52, 8
  v_lshl_add_u32 v10, v1, 2, s66
  s_mov_b32 s77, 0
  s_cmp_eq_u32 s52, 3
  s_cbranch_scc1 L_nopf
  s_cmp_lg_u32 s52, 0
  s_cbranch_scc1 L_pfq
  s_mul_i32 s67, s53, 98304
  s_lshl_b32 s68, s3, 8
  s_add_u32 s67, s67, s68
  s_mov_b32 s46, 3145728
  v_mul_u32_u24 v18, 6144, v3
  v_lshl_add_u32 v18, v2, 7, v18
  s_mov_b32 exec_hi, 0
  s_waitcnt lgkmcnt(0)
  s_mov_b64 s[44:45], s[24:25]
  buffer_load_dword v30, v18, s[44:47], s67 offen
  s_mov_b64 exec, -1
L_nopf:
  s_cmp_ge_u32 s53, 16
  s_cbranch_scc1 L_T2
  s_cmp_ge_u32 s53, 8
  s_cbranch_scc1 L_TQ
  s_cmp_ge_u32 s53, 4
  s_cbranch_scc1 L_T2
  s_lshl2_add_u32 s75, s3, s53
  s_mov_b32 s77, 1
  v_lshrrev_b32 v16, 2, v3
  v_lshl_add_u32 v16, v2, 4, v16
  v_mul_u32_u24 v16, 12288, v16
  v_and_b32 v17, 3, v3
  v_lshl_add_u32 v16, v17, 4, v16
  s_mul_i32 s66, s52, 786432
  s_lshl_b32 s67, s75, 6
  s_add_u32 s66, s66, s67
  s_mov_b32 s46, 3145728
  s_waitcnt lgkmcnt(0)
  s_mov_b64 s[44:45], s[24:25]
  s_mov_b64 s[48:49], s[22:23]
  buffer_load_dword v24, v10, s[48:51], 0 offen
  buffer_load_dwordx4 v[32:35], v16, s[44:47], s66 offen
  s_add_u32 s66, s66, 6144
  buffer_load_dwordx4 v[36:39], v16, s[44:47], s66 offen
  s_add_u32 s66, s66, 43008
  buffer_load_dwordx4 v[40:43], v16, s[44:47], s66 offen
  s_add_u32 s66, s66, 6144
  buffer_load_dwordx4 v[44:47], v16, s[44:47], s66 offen
  s_add_u32 s66, s66, 43008
  buffer_load_dwordx4 v[48:51], v16, s[44:47], s66 offen
  s_add_u32 s66, s66, 6144
  buffer_load_dwordx4 v[52:55], v16, s[44:47], s66 offen
  s_add_u32 s66, s66, 43008
  buffer_load_dwordx4 v[56:59], v16, s[44:47], s66 offen
  s_add_u32 s66, s66, 6144
  buffer_load_dwordx4 v[60:63], v16, s[44:47], s66 offen
  s_add_u32 s66, s66, 43008
  s_branch L_T2
L_pfq:
  s_mov_b32 s46, 4194304
  s_lshl_b32 s68, s3, 10
  s_cmp_ge_u32 s53, 16
  s_cbranch_scc1 L_pfq2
  s_sub_u32 s66, s53, 4
  s_cmp_lt_u32 s66, 4
  s_cselect_b32 s67, s52, 0
  s_cmp_lg_u32 s67, 1
  s_cbranch_scc1 L_nopf
  s_lshl_b32 s67, s66, 20
  s_add_u32 s67, s67, s68
  s_add_u32 s67, s67, 0x180
  v_lshlrev_b32 v18, 18, v2
  v_lshl_add_u32 v18, v3, 13, v18
  s_branch L_pfq3
L_pfq2:
  s_sub_u32 s66, s53, 16
  s_lshl_b32 s67, s66, 18
  s_add_u32 s67, s67, s68
  s_add_u32 s66, s52, 1
  s_lshl_b32 s66, s66, 16
  s_add_u32 s67, s67, s66
  v_lshrrev_b32 v18, 3, v1
  v_lshlrev_b32 v18, 13, v18
  v_and_b32 v19, 7, v1
  v_lshl_add_u32 v18, v19, 7, v18
L_pfq3:
  s_waitcnt lgkmcnt(0)
  s_mov_b64 s[44:45], s[10:11]
  buffer_load_dword v30, v18, s[44:47], s67 offen
  s_branch L_T2
L_TQ:
  s_lshl3_add_u32 s75, s3, s53
  s_sub_u32 s75, s75, 8
  s_mov_b32 s77, 2
  v_lshrrev_b32 v16, 3, v3
  v_lshl_add_u32 v16, v2, 4, v16
  v_lshlrev_b32 v16, 14, v16
  v_and_b32 v17, 7, v3
  v_lshl_add_u32 v16, v17, 4, v16
  s_lshl_b32 s66, s52, 20
  s_lshl_b32 s67, s75, 7
  s_add_u32 s66, s66, s67
  s_mov_b32 s46, 4194304
  v_lshlrev_b32 v17, 4, v1
  s_waitcnt lgkmcnt(0)
  s_mov_b64 s[44:45], s[10:11]
  s_mov_b64 s[48:49], s[4:5]
  buffer_load_dword v24, v10, s[48:51], 0 offen
  buffer_load_dwordx4 v[20:23], v17, s[48:51], 0 offen
  s_add_u32 s67, s66, 0
  buffer_load_dwordx4 v[128:131], v16, s[44:47], s67 offen nt
  s_add_u32 s67, s66, 32768
  buffer_load_dwordx4 v[160:163], v16, s[44:47], s67 offen nt
  s_add_u32 s67, s66, 8192
  buffer_load_dwordx4 v[132:135], v16, s[44:47], s67 offen nt
  s_add_u32 s67, s66, 40960
  buffer_load_dwordx4 v[164:167], v16, s[44:47], s67 offen nt
  s_add_u32 s67, s66, 65536
  buffer_load_dwordx4 v[136:139], v16, s[44:47], s67 offen nt
  s_add_u32 s67, s66, 98304
  buffer_load_dwordx4 v[168:171], v16, s[44:47], s67 offen nt
  s_add_u32 s67, s66, 73728
  buffer_load_dwordx4 v[140:143], v16, s[44:47], s67 offen nt
  s_add_u32 s67, s66, 106496
  buffer_load_dwordx4 v[172:175], v16, s[44:47], s67 offen nt
  s_add_u32 s67, s66, 131072
  buffer_load_dwordx4 v[144:147], v16, s[44:47], s67 offen nt
  s_add_u32 s67, s66, 163840
  buffer_load_dwordx4 v[176:179], v16, s[44:47], s67 offen nt
  s_add_u32 s67, s66, 139264
  buffer_load_dwordx4 v[148:151], v16, s[44:47], s67 offen nt
  s_add_u32 s67, s66, 172032
  buffer_load_dwordx4 v[180:183], v16, s[44:47], s67 offen nt
  s_add_u32 s67, s66, 196608
  buffer_load_dwordx4 v[152:155], v16, s[44:47], s67 offen nt
  s_add_u32 s67, s66, 229376
  buffer_load_dwordx4 v[184:187], v16, s[44:47], s67 offen nt
  s_add_u32 s67, s66, 204800
  buffer_load_dwordx4 v[156:159], v16, s[44:47], s67 offen nt
  s_add_u32 s67, s66, 237568
  buffer_load_dwordx4 v[188:191], v16, s[44:47], s67 offen nt
L_T2:
  s_waitcnt lgkmcnt(0)
  s_barrier
  s_load_dword s56, s[30:31], 98304
  s_branch L_T3
L_stream:
  v_bfe_u32 v4, v3, 1, 1
  v_lshlrev_b32 v4, 10, v4
  v_lshrrev_b32 v5, 2, v3
  v_lshl_add_u32 v4, v5, 8, v4
  v_lshl_add_u32 v4, v2, 5, v4
  v_and_b32 v5, 1, v3
  v_lshl_add_u32 v4, v5, 4, v4
  v_add_u32 v5, 0x1000, v4
  v_lshlrev_b32 v6, 4, v1
  v_add_u32 v7, 0x1000, v6
  s_lshr_b32 s54, s53, 3
  s_add_u32 s54, s54, s3
  s_and_b32 s54, s54, 3
  s_add_u32 s55, s53, s3
  s_and_b32 s55, s55, 7
  s_lshl_b32 s67, s55, 2
  s_add_u32 s54, s54, s67
  s_and_b32 s67, s54, 3
  s_lshl_b32 s77, s67, 3
  s_add_u32 s77, s77, s3
  s_lshl_b32 s79, s67, 20
  s_and_b32 s68, s52, 1
  s_lshl_b32 s67, s68, 13
  s_add_u32 s79, s79, s67
  s_lshl_b32 s67, s3, 14
  s_add_u32 s49, s79, s67
  s_bfe_u32 s70, s52, 0x10001
  s_mul_i32 s70, s70, 262144
  s_add_u32 s70, s70, s49
  s_lshl_b32 s66, s55, 24
  s_mov_b32 s34, 0x1000000
  s_mov_b32 s35, 0x20000
  s_mov_b32 s38, 0x1000000
  s_mov_b32 s39, 0x20000
  s_add_u32 s71, s70, 4194304
  s_add_u32 s72, s70, 8388608
  s_add_u32 s73, s70, 12582912
  s_sub_u32 s48, s53, 4
  s_cmp_lt_u32 s48, 4
  s_cselect_b32 s48, 16, s53
  s_waitcnt lgkmcnt(0)
  s_load_dword s56, s[30:31], 98304
  s_add_u32 s32, s6, s66
  s_addc_u32 s33, s7, 0
  s_add_u32 s36, s8, s66
  s_addc_u32 s37, s9, 0
  s_cmp_lt_u32 s48, 16
  s_cbranch_scc1 L_q0
  buffer_load_dwordx4 v[128:131], v4, s[32:35], s70 offen offset:0 nt
  buffer_load_dwordx4 v[132:135], v4, s[32:35], s70 offen offset:128 nt
  buffer_load_dwordx4 v[136:139], v4, s[32:35], s70 offen offset:2048 nt
  buffer_load_dwordx4 v[140:143], v4, s[32:35], s70 offen offset:2176 nt
  buffer_load_dwordx4 v[144:147], v5, s[32:35], s70 offen offset:0 nt
  buffer_load_dwordx4 v[148:151], v5, s[32:35], s70 offen offset:128 nt
  buffer_load_dwordx4 v[152:155], v5, s[32:35], s70 offen offset:2048 nt
  buffer_load_dwordx4 v[156:159], v5, s[32:35], s70 offen offset:2176 nt
L_q0:
  s_barrier
  s_mov_b64 s[40:41], s[30:31]
  s_mov_b32 s42, 2097152
  s_mov_b32 s43, 0x20000
  s_mov_b32 s60, 0x05040100
  s_mov_b32 s61, 0x07060302
  s_mov_b32 s62, 0xffff0000
  s_mov_b32 s63, 0x3fb8aa3b
  s_mov_b32 s64, 0xff
  s_mov_b32 s65, 1600000
  s_lshl_b32 s69, s54, 1
  s_add_u32 s69, s69, s68
  s_mul_i32 s69, s69, 1024
  s_add_u32 s28, s30, 131072
  s_addc_u32 s29, s31, 0
  v_and_b32 v16, 3, v3
  v_lshlrev_b32 v16, 8, v16
  v_lshl_add_u32 v16, v2, 5, v16
  v_bfe_u32 v17, v3, 2, 1
  v_lshl_add_u32 v16, v17, 4, v16
  v_mov_b32 v32, 0
  v_mov_b32 v33, 0
  v_mov_b32 v34, 0
  v_mov_b32 v35, 0
  v_mov_b32 v36, 0
  v_mov_b32 v37, 0
  v_mov_b32 v38, 0
  v_mov_b32 v39, 0
  v_mov_b32 v40, 0
  v_mov_b32 v41, 0
  v_mov_b32 v42, 0
  v_mov_b32 v43, 0
  v_mov_b32 v44, 0
  v_mov_b32 v45, 0
  v_mov_b32 v46, 0
  v_mov_b32 v47, 0
  v_mov_b32 v48, 0
  v_mov_b32 v49, 0
  v_mov_b32 v50, 0
  v_mov_b32 v51, 0
  v_mov_b32 v52, 0
  v_mov_b32 v53, 0
  v_mov_b32 v54, 0
  v_mov_b32 v55, 0
  v_mov_b32 v56, 0
  v_mov_b32 v57, 0
  v_mov_b32 v58, 0
  v_mov_b32 v59, 0
  v_mov_b32 v60, 0
  v_mov_b32 v61, 0
  v_mov_b32 v62, 0
  v_mov_b32 v63, 0
  v_mov_b32 v84, 0xff800000
  v_mov_b32 v93, 0xff800000
  v_mov_b32 v85, 0
  v_mov_b32 v86, 0
  v_mov_b32 v87, 0
  v_mov_b32 v88, 0
  v_mov_b32 v0, 0
  v_mov_b32 v2, 1
  v_mov_b32 v3, 16
  s_lshl_b32 s66, s55, 1
  s_and_b32 s67, s52, 1
  s_add_u32 s66, s66, s67
  s_lshl_b32 s66, s66, 5
  s_add_u32 s66, s66, s77
  s_mul_i32 s75, s66, 1152
  s_add_u32 s75, s75, 393216
  s_waitcnt lgkmcnt(0)
  s_add_u32 s56, s56, 1
  s_and_b32 s56, s56, 0xff
  s_add_u32 s57, s56, 37
  s_and_b32 s57, s57, 0xff
  s_add_u32 s58, s56, 74
  s_and_b32 s58, s58, 0xff
  s_add_u32 s59, s56, 111
  s_and_b32 s59, s59, 0xff
  s_cmp_ge_u32 s48, 16
  s_cbranch_scc1 L_noquiet
  buffer_load_dwordx4 v[128:131], v4, s[32:35], s70 offen offset:0 nt
  buffer_load_dwordx4 v[132:135], v4, s[32:35], s70 offen offset:128 nt
  buffer_load_dwordx4 v[136:139], v4, s[32:35], s70 offen offset:2048 nt
  buffer_load_dwordx4 v[140:143], v4, s[32:35], s70 offen offset:2176 nt
L_lw_1:
  ds_read_b32 v17, v0 offset:1284
  s_waitcnt lgkmcnt(0)
  v_cmp_eq_u32 vcc, 5, v17
  s_cbranch_vccnz L_lwok_2
  s_sleep 2
  s_sub_u32 s65, s65, 1
  s_cbranch_scc1 L_fin
  s_branch L_lw_1
L_lwok_2:
L_q1:
  buffer_load_dwordx4 v[144:147], v5, s[32:35], s70 offen offset:0 nt
  buffer_load_dwordx4 v[148:151], v5, s[32:35], s70 offen offset:128 nt
  buffer_load_dwordx4 v[152:155], v5, s[32:35], s70 offen offset:2048 nt
  buffer_load_dwordx4 v[156:159], v5, s[32:35], s70 offen offset:2176 nt
L_noquiet:
  s_waitcnt vmcnt(7)
  buffer_load_dwordx4 v[160:163], v4, s[32:35], s71 offen offset:0 nt
  s_waitcnt vmcnt(7)
  buffer_load_dwordx4 v[164:167], v4, s[32:35], s71 offen offset:128 nt
  s_waitcnt vmcnt(7)
  buffer_load_dwordx4 v[168:171], v4, s[32:35], s71 offen offset:2048 nt
  s_waitcnt vmcnt(7)
  buffer_load_dwordx4 v[172:175], v4, s[32:35], s71 offen offset:2176 nt
  s_waitcnt vmcnt(7)
  buffer_load_dwordx4 v[176:179], v5, s[32:35], s71 offen offset:0 nt
  s_waitcnt vmcnt(7)
  buffer_load_dwordx4 v[180:183], v5, s[32:35], s71 offen offset:128 nt
  s_waitcnt vmcnt(7)
  buffer_load_dwordx4 v[184:187], v5, s[32:35], s71 offen offset:2048 nt
  s_waitcnt vmcnt(7)
  buffer_load_dwordx4 v[188:191], v5, s[32:35], s71 offen offset:2176 nt
  s_waitcnt vmcnt(7)
  buffer_load_dwordx4 v[192:195], v4, s[32:35], s72 offen offset:0 nt
  s_waitcnt vmcnt(7)
  buffer_load_dwordx4 v[196:199], v4, s[32:35], s72 offen offset:128 nt
  s_waitcnt vmcnt(7)
  buffer_load_dwordx4 v[200:203], v4, s[32:35], s72 offen offset:2048 nt
  s_waitcnt vmcnt(7)
  buffer_load_dwordx4 v[204:207], v4, s[32:35], s72 offen offset:2176 nt
  s_waitcnt vmcnt(7)
  buffer_load_dwordx4 v[208:211], v5, s[32:35], s72 offen offset:0 nt
  s_waitcnt vmcnt(7)
  buffer_load_dwordx4 v[212:215], v5, s[32:35], s72 offen offset:128 nt
  s_waitcnt vmcnt(7)
  buffer_load_dwordx4 v[216:219], v5, s[32:35], s72 offen offset:2048 nt
  s_waitcnt vmcnt(7)
  buffer_load_dwordx4 v[220:223], v5, s[32:35], s72 offen offset:2176 nt
  s_waitcnt vmcnt(7)
  buffer_load_dwordx4 v[224:227], v4, s[32:35], s73 offen offset:0 nt
  s_waitcnt vmcnt(7)
  buffer_load_dwordx4 v[228:231], v4, s[32:35], s73 offen offset:128 nt
  s_waitcnt vmcnt(7)
  buffer_load_dwordx4 v[232:235], v4, s[32:35], s73 offen offset:2048 nt
  s_waitcnt vmcnt(7)
  buffer_load_dwordx4 v[236:239], v4, s[32:35], s73 offen offset:2176 nt
  s_waitcnt vmcnt(7)
  buffer_load_dwordx4 v[240:243], v5, s[32:35], s73 offen offset:0 nt
  s_waitcnt vmcnt(7)
  buffer_load_dwordx4 v[244:247], v5, s[32:35], s73 offen offset:128 nt
  s_waitcnt vmcnt(7)
  buffer_load_dwordx4 v[248:251], v5, s[32:35], s73 offen offset:2048 nt
  s_waitcnt vmcnt(7)
  buffer_load_dwordx4 v[252:255], v5, s[32:35], s73 offen offset:2176 nt
  s_cmp_ge_u32 s52, 6
  s_cbranch_scc1 L_nodma
  s_and_b32 s66, s52, 1
  s_mul_i32 s51, s66, 32768
  s_add_u32 s51, s51, 20480
  v_add_u32 v127, s51, v6
  s_mov_b32 s72, 4
L_dma:
  s_and_b32 s66, s72, 3
  s_lshl_b32 s66, s66, 22
  s_lshr_b32 s67, s72, 2
  s_lshl_b32 s67, s67, 17
  s_add_u32 s66, s66, s67
  s_add_u32 s70, s66, s49
  s_add_u32 s72, s72, 1
  s_add_u32 m0, s51, 0
  s_waitcnt vmcnt(15)
  buffer_load_dwordx4 v4, s[32:35], s70 offen offset:0 nt lds
  s_add_u32 m0, s51, 896
  s_waitcnt vmcnt(15)
  buffer_load_dwordx4 v4, s[32:35], s70 offen offset:128 nt lds
  s_add_u32 m0, s51, 0
  s_waitcnt vmcnt(15)
  buffer_load_dwordx4 v4, s[32:35], s70 offen offset:2048 nt lds
  s_add_u32 m0, s51, 896
  s_waitcnt vmcnt(15)
  buffer_load_dwordx4 v4, s[32:35], s70 offen offset:2176 nt lds
  s_add_u32 m0, s51, 4096
  s_waitcnt vmcnt(15)
  buffer_load_dwordx4 v5, s[32:35], s70 offen offset:0 nt lds
  s_add_u32 m0, s51, 4992
  s_waitcnt vmcnt(15)
  buffer_load_dwordx4 v5, s[32:35], s70 offen offset:128 nt lds
  s_add_u32 m0, s51, 4096
  s_waitcnt vmcnt(15)
  buffer_load_dwordx4 v5, s[32:35], s70 offen offset:2048 nt lds
  s_add_u32 m0, s51, 4992
  s_waitcnt vmcnt(15)
  buffer_load_dwordx4 v5, s[32:35], s70 offen offset:2176 nt lds
  s_add_u32 s51, s51, 0x2000
  s_cmp_lt_u32 s72, 8
  s_cbranch_scc1 L_dma
  s_waitcnt vmcnt(0)
L_nodma:
  s_cmp_ge_u32 s52, 6
  s_cselect_b32 s72, 12, 4
  s_cselect_b32 s73, 25, 8
  s_cselect_b32 s14, 8, 0
  s_cselect_b32 s47, 1, 5
  s_mov_b32 s15, s73
  s_mov_b32 s51, 0
  s_mov_b32 s50, 0
  s_mov_b64 s[22:23], 0
  s_mov_b32 s6, 0
  s_mov_b32 s7, s49
  s_mov_b32 s8, 17
  s_sub_u32 s66, s53, 16
  s_cmp_lt_u32 s66, 7
  s_cselect_b32 s48, 40, -1
  s_mov_b32 s78, 0
  s_mov_b32 s46, 2
  s_mov_b32 s44, 0
  s_mov_b32 s45, 0
L_qspin:
  ds_read_b32 v17, v0 offset:1280
  ds_read_b128 v[8:11], v16 offset:0
  ds_read_b128 v[12:15], v16 offset:128
  s_waitcnt lgkmcnt(0)
  v_cmp_ne_u32 vcc, 0, v17
  s_cbranch_vccnz L_qok
  s_sleep 2
  s_sub_u32 s65, s65, 1
  s_cbranch_scc1 L_fin
  s_branch L_qspin
L_qok:
L_loop_start:
L_s0:
  s_and_b32 s76, s50, 3
  s_lshr_b32 s50, s50, 2
  s_cmp_eq_u32 s76, 0
  s_cbranch_scc1 L_w0
  s_cmp_eq_u32 s76, 2
  s_cbranch_scc1 L_vf0
L_vp0:
  s_set_gpr_idx_on s45, gpr_idx(SRC0)
  s_nop 0
  v_mov_b32 v89, v96
  s_set_gpr_idx_off
  s_add_u32 s45, s45, 1
  v_lshlrev_b32 v90, 16, v89
  v_and_b32 v91, s62, v89
  v_fma_f32 v90, v90, s63, -v85
  v_fma_f32 v91, v91, s63, -v85
  v_exp_f32 v90, v90
  v_exp_f32 v91, v91
  s_cmp_eq_u32 s50, 3
  v_add_f32 v86, v86, v90
  v_cvt_pk_bf16_f32 v64, v90, v91
  v_add_f32 v86, v86, v91
  s_nop 0
  v_mov_b32_dpp v65, v64 row_shl:4 row_mask:0xf bank_mask:0xf bound_ctrl:0
  v_mov_b32_dpp v66, v64 row_shl:8 row_mask:0xf bank_mask:0xf bound_ctrl:0
  v_mov_b32_dpp v67, v64 row_shl:12 row_mask:0xf bank_mask:0xf bound_ctrl:0
  s_cbranch_scc1 L_last0
L_w0:
  s_waitcnt vmcnt(8)
  s_sub_u32 s46, s46, 1
  s_cbranch_scc0 L_go0
  s_mov_b32 s46, 0
  s_mov_b32 s9, 0
  s_cmp_lt_u32 s72, s73
  s_cbranch_scc0 L_nb
  s_lshl2_add_u32 s50, s51, s50
L_hv0:
  s_and_b32 s66, s72, 3
  s_lshl_b32 s66, s66, 22
  s_lshr_b32 s67, s72, 2
  s_lshl_b32 s67, s67, 17
  s_add_u32 s66, s66, s67
  s_add_u32 s70, s66, s49
  s_add_u32 s72, s72, 1
  s_cmp_lg_u32 s51, 0
  s_cbranch_scc1 L_iv0
  s_cmp_lt_u32 s52, 6
  s_cbranch_scc1 L_ld0
  buffer_load_dwordx4 v[192:195], v4, s[32:35], s70 offen offset:0 nt
  buffer_load_dwordx4 v[196:199], v4, s[32:35], s70 offen offset:128 nt
  buffer_load_dwordx4 v[200:203], v4, s[32:35], s70 offen offset:2048 nt
  buffer_load_dwordx4 v[204:207], v4, s[32:35], s70 offen offset:2176 nt
  buffer_load_dwordx4 v[208:211], v5, s[32:35], s70 offen offset:0 nt
  buffer_load_dwordx4 v[212:215], v5, s[32:35], s70 offen offset:128 nt
  buffer_load_dwordx4 v[216:219], v5, s[32:35], s70 offen offset:2048 nt
  buffer_load_dwordx4 v[220:223], v5, s[32:35], s70 offen offset:2176 nt
  s_cmp_lg_u32 s47, 1
  s_cbranch_scc1 L_go0
  s_add_u32 s66, s72, 1
  s_cmp_lt_u32 s66, s73
  s_cbranch_scc1 L_go0
  s_mov_b32 s47, 3
  s_branch L_rq0
L_iv0:
  buffer_load_dwordx4 v[192:195], v6, s[36:39], s70 offen offset:0 nt
  buffer_load_dwordx4 v[196:199], v6, s[36:39], s70 offen offset:1024 nt
  buffer_load_dwordx4 v[200:203], v6, s[36:39], s70 offen offset:2048 nt
  buffer_load_dwordx4 v[204:207], v6, s[36:39], s70 offen offset:3072 nt
  buffer_load_dwordx4 v[208:211], v7, s[36:39], s70 offen offset:0 nt
  buffer_load_dwordx4 v[212:215], v7, s[36:39], s70 offen offset:1024 nt
  buffer_load_dwordx4 v[216:219], v7, s[36:39], s70 offen offset:2048 nt
  buffer_load_dwordx4 v[220:223], v7, s[36:39], s70 offen offset:3072 nt
  s_cmp_lt_u32 s72, s73
  s_cbranch_scc1 L_go0
  s_cmp_lg_u32 s6, 0
  s_cbranch_scc1 L_go0
  s_cmp_lt_u32 s52, 6
  s_cbranch_scc1 L_go0
  s_cmp_ge_u32 s78, s48
  s_cselect_b32 s78, 0x400, s78
  s_cbranch_scc1 L_go0
L_rq0:
  s_mov_b32 s78, 1
  s_atomic_add s78, s[28:29], s69 glc
L_go0:
  s_cmp_lg_u32 s76, 0
  s_cbranch_scc1 L_pv0
  v_mfma_f32_16x16x32_bf16 v[16:19], v[128:131], v[8:11], 0
  v_mfma_f32_16x16x32_bf16 v[20:23], v[136:139], v[8:11], 0
  v_mfma_f32_16x16x32_bf16 v[24:27], v[144:147], v[8:11], 0
  v_mfma_f32_16x16x32_bf16 v[28:31], v[152:155], v[8:11], 0
  v_mfma_f32_16x16x32_bf16 v[16:19], v[132:135], v[12:15], v[16:19]
  v_mfma_f32_16x16x32_bf16 v[20:23], v[140:143], v[12:15], v[20:23]
  v_mfma_f32_16x16x32_bf16 v[24:27], v[148:151], v[12:15], v[24:27]
  v_mfma_f32_16x16x32_bf16 v[28:31], v[156:159], v[12:15], v[28:31]
  s_nop 4
  v_add_f32_dpp v87, v17, v16 row_shl:4 row_mask:0xf bank_mask:0x1
  v_add_f32_dpp v88, v19, v18 row_shl:4 row_mask:0xf bank_mask:0x1
  s_nop 0
  v_add_f32_dpp v87, v20, v21 row_shr:4 row_mask:0xf bank_mask:0x2
  v_add_f32_dpp v88, v22, v23 row_shr:4 row_mask:0xf bank_mask:0x2
  s_nop 0
  v_add_f32_dpp v87, v25, v24 row_shl:4 row_mask:0xf bank_mask:0x4
  v_add_f32_dpp v88, v27, v26 row_shl:4 row_mask:0xf bank_mask:0x4
  s_nop 0
  v_add_f32_dpp v87, v28, v29 row_shr:4 row_mask:0xf bank_mask:0x8
  v_add_f32_dpp v88, v30, v31 row_shr:4 row_mask:0xf bank_mask:0x8
  v_cvt_pk_bf16_f32 v89, v87, v88
  v_lshlrev_b32 v90, 16, v89
  v_and_b32 v91, s62, v89
  v_mul_f32 v90, 0x3db504f3, v90
  v_mul_f32 v91, 0x3db504f3, v91
  v_cvt_pk_bf16_f32 v89, v90, v91
  s_set_gpr_idx_on s44, gpr_idx(DST)
  s_nop 0
  v_mov_b32 v96, v89
  s_set_gpr_idx_off
  s_add_u32 s44, s44, 1
  v_lshlrev_b32 v90, 16, v89
  v_and_b32 v91, s62, v89
  v_max3_f32 v93, v90, v91, v93
  s_branch L_s1
L_pv0:
  v_perm_b32 v68, v132, v128, s60
  v_perm_b32 v69, v140, v136, s60
  v_perm_b32 v70, v148, v144, s60
  v_perm_b32 v71, v156, v152, s60
  v_perm_b32 v72, v132, v128, s61
  v_perm_b32 v73, v140, v136, s61
  v_perm_b32 v74, v148, v144, s61
  v_perm_b32 v75, v156, v152, s61
  v_perm_b32 v76, v133, v129, s60
  v_perm_b32 v77, v141, v137, s60
  v_perm_b32 v78, v149, v145, s60
  v_perm_b32 v79, v157, v153, s60
  v_perm_b32 v80, v133, v129, s61
  v_perm_b32 v81, v141, v137, s61
  v_perm_b32 v82, v149, v145, s61
  v_perm_b32 v83, v157, v153, s61
  v_mfma_f32_16x16x32_bf16 v[32:35], v[68:71], v[64:67], v[32:35]
  v_mfma_f32_16x16x32_bf16 v[36:39], v[72:75], v[64:67], v[36:39]
  v_perm_b32 v68, v134, v130, s60
  v_perm_b32 v69, v142, v138, s60
  v_perm_b32 v70, v150, v146, s60
  v_perm_b32 v71, v158, v154, s60
  v_perm_b32 v72, v134, v130, s61
  v_perm_b32 v73, v142, v138, s61
  v_perm_b32 v74, v150, v146, s61
  v_perm_b32 v75, v158, v154, s61
  v_mfma_f32_16x16x32_bf16 v[40:43], v[76:79], v[64:67], v[40:43]
  v_mfma_f32_16x16x32_bf16 v[44:47], v[80:83], v[64:67], v[44:47]
  v_perm_b32 v76, v135, v131, s60
  v_perm_b32 v77, v143, v139, s60
  v_perm_b32 v78, v151, v147, s60
  v_perm_b32 v79, v159, v155, s60
  v_perm_b32 v80, v135, v131, s61
  v_perm_b32 v81, v143, v139, s61
  v_perm_b32 v82, v151, v147, s61
  v_perm_b32 v83, v159, v155, s61
  v_mfma_f32_16x16x32_bf16 v[48:51], v[68:71], v[64:67], v[48:51]
  v_mfma_f32_16x16x32_bf16 v[52:55], v[72:75], v[64:67], v[52:55]
  v_mfma_f32_16x16x32_bf16 v[56:59], v[76:79], v[64:67], v[56:59]
  v_mfma_f32_16x16x32_bf16 v[60:63], v[80:83], v[64:67], v[60:63]
L_s1:
  s_and_b32 s76, s50, 3
  s_lshr_b32 s50, s50, 2
  s_cmp_eq_u32 s76, 0
  s_cbranch_scc1 L_w1
  s_cmp_eq_u32 s76, 2
  s_cbranch_scc1 L_vf1
L_vp1:
  s_set_gpr_idx_on s45, gpr_idx(SRC0)
  s_nop 0
  v_mov_b32 v89, v96
  s_set_gpr_idx_off
  s_add_u32 s45, s45, 1
  v_lshlrev_b32 v90, 16, v89
  v_and_b32 v91, s62, v89
  v_fma_f32 v90, v90, s63, -v85
  v_fma_f32 v91, v91, s63, -v85
  v_exp_f32 v90, v90
  v_exp_f32 v91, v91
  s_cmp_eq_u32 s50, 3
  v_add_f32 v86, v86, v90
  v_cvt_pk_bf16_f32 v64, v90, v91
  v_add_f32 v86, v86, v91
  s_nop 0
  v_mov_b32_dpp v65, v64 row_shl:4 row_mask:0xf bank_mask:0xf bound_ctrl:0
  v_mov_b32_dpp v66, v64 row_shl:8 row_mask:0xf bank_mask:0xf bound_ctrl:0
  v_mov_b32_dpp v67, v64 row_shl:12 row_mask:0xf bank_mask:0xf bound_ctrl:0
  s_cbranch_scc1 L_last1
L_w1:
  s_waitcnt vmcnt(8)
  s_sub_u32 s46, s46, 1
  s_cbranch_scc0 L_go1
  s_mov_b32 s46, 0
  s_mov_b32 s9, 1
  s_cmp_lt_u32 s72, s73
  s_cbranch_scc0 L_nb
  s_lshl2_add_u32 s50, s51, s50
L_hv1:
  s_and_b32 s66, s72, 3
  s_lshl_b32 s66, s66, 22
  s_lshr_b32 s67, s72, 2
  s_lshl_b32 s67, s67, 17
  s_add_u32 s66, s66, s67
  s_add_u32 s70, s66, s49
  s_add_u32 s72, s72, 1
  s_cmp_lg_u32 s51, 0
  s_cbranch_scc1 L_iv1
  s_cmp_lt_u32 s52, 6
  s_cbranch_scc1 L_ld1
  buffer_load_dwordx4 v[224:227], v4, s[32:35], s70 offen offset:0 nt
  buffer_load_dwordx4 v[228:231], v4, s[32:35], s70 offen offset:128 nt
  buffer_load_dwordx4 v[232:235], v4, s[32:35], s70 offen offset:2048 nt
  buffer_load_dwordx4 v[236:239], v4, s[32:35], s70 offen offset:2176 nt
  buffer_load_dwordx4 v[240:243], v5, s[32:35], s70 offen offset:0 nt
  buffer_load_dwordx4 v[244:247], v5, s[32:35], s70 offen offset:128 nt
  buffer_load_dwordx4 v[248:251], v5, s[32:35], s70 offen offset:2048 nt
  buffer_load_dwordx4 v[252:255], v5, s[32:35], s70 offen offset:2176 nt
  s_cmp_lg_u32 s47, 1
  s_cbranch_scc1 L_go1
  s_add_u32 s66, s72, 1
  s_cmp_lt_u32 s66, s73
  s_cbranch_scc1 L_go1
  s_mov_b32 s47, 3
  s_branch L_rq1
L_iv1:
  buffer_load_dwordx4 v[224:227], v6, s[36:39], s70 offen offset:0 nt
  buffer_load_dwordx4 v[228:231], v6, s[36:39], s70 offen offset:1024 nt
  buffer_load_dwordx4 v[232:235], v6, s[36:39], s70 offen offset:2048 nt
  buffer_load_dwordx4 v[236:239], v6, s[36:39], s70 offen offset:3072 nt
  buffer_load_dwordx4 v[240:243], v7, s[36:39], s70 offen offset:0 nt
  buffer_load_dwordx4 v[244:247], v7, s[36:39], s70 offen offset:1024 nt
  buffer_load_dwordx4 v[248:251], v7, s[36:39], s70 offen offset:2048 nt
  buffer_load_dwordx4 v[252:255], v7, s[36:39], s70 offen offset:3072 nt
  s_cmp_lt_u32 s72, s73
  s_cbranch_scc1 L_go1
  s_cmp_lg_u32 s6, 0
  s_cbranch_scc1 L_go1
  s_cmp_lt_u32 s52, 6
  s_cbranch_scc1 L_go1
  s_cmp_ge_u32 s78, s48
  s_cselect_b32 s78, 0x400, s78
  s_cbranch_scc1 L_go1
L_rq1:
  s_mov_b32 s78, 1
  s_atomic_add s78, s[28:29], s69 glc
L_go1:
  s_cmp_lg_u32 s76, 0
  s_cbranch_scc1 L_pv1
  v_mfma_f32_16x16x32_bf16 v[16:19], v[160:163], v[8:11], 0
  v_mfma_f32_16x16x32_bf16 v[20:23], v[168:171], v[8:11], 0
  v_mfma_f32_16x16x32_bf16 v[24:27], v[176:179], v[8:11], 0
  v_mfma_f32_16x16x32_bf16 v[28:31], v[184:187], v[8:11], 0
  v_mfma_f32_16x16x32_bf16 v[16:19], v[164:167], v[12:15], v[16:19]
  v_mfma_f32_16x16x32_bf16 v[20:23], v[172:175], v[12:15], v[20:23]
  v_mfma_f32_16x16x32_bf16 v[24:27], v[180:183], v[12:15], v[24:27]
  v_mfma_f32_16x16x32_bf16 v[28:31], v[188:191], v[12:15], v[28:31]
  s_nop 4
  v_add_f32_dpp v87, v17, v16 row_shl:4 row_mask:0xf bank_mask:0x1
  v_add_f32_dpp v88, v19, v18 row_shl:4 row_mask:0xf bank_mask:0x1
  s_nop 0
  v_add_f32_dpp v87, v20, v21 row_shr:4 row_mask:0xf bank_mask:0x2
  v_add_f32_dpp v88, v22, v23 row_shr:4 row_mask:0xf bank_mask:0x2
  s_nop 0
  v_add_f32_dpp v87, v25, v24 row_shl:4 row_mask:0xf bank_mask:0x4
  v_add_f32_dpp v88, v27, v26 row_shl:4 row_mask:0xf bank_mask:0x4
  s_nop 0
  v_add_f32_dpp v87, v28, v29 row_shr:4 row_mask:0xf bank_mask:0x8
  v_add_f32_dpp v88, v30, v31 row_shr:4 row_mask:0xf bank_mask:0x8
  v_cvt_pk_bf16_f32 v89, v87, v88
  v_lshlrev_b32 v90, 16, v89
  v_and_b32 v91, s62, v89
  v_mul_f32 v90, 0x3db504f3, v90
  v_mul_f32 v91, 0x3db504f3, v91
  v_cvt_pk_bf16_f32 v89, v90, v91
  s_set_gpr_idx_on s44, gpr_idx(DST)
  s_nop 0
  v_mov_b32 v96, v89
  s_set_gpr_idx_off
  s_add_u32 s44, s44, 1
  v_lshlrev_b32 v90, 16, v89
  v_and_b32 v91, s62, v89
  v_max3_f32 v93, v90, v91, v93
  s_branch L_s2
L_pv1:
  v_perm_b32 v68, v164, v160, s60
  v_perm_b32 v69, v172, v168, s60
  v_perm_b32 v70, v180, v176, s60
  v_perm_b32 v71, v188, v184, s60
  v_perm_b32 v72, v164, v160, s61
  v_perm_b32 v73, v172, v168, s61
  v_perm_b32 v74, v180, v176, s61
  v_perm_b32 v75, v188, v184, s61
  v_perm_b32 v76, v165, v161, s60
  v_perm_b32 v77, v173, v169, s60
  v_perm_b32 v78, v181, v177, s60
  v_perm_b32 v79, v189, v185, s60
  v_perm_b32 v80, v165, v161, s61
  v_perm_b32 v81, v173, v169, s61
  v_perm_b32 v82, v181, v177, s61
  v_perm_b32 v83, v189, v185, s61
  v_mfma_f32_16x16x32_bf16 v[32:35], v[68:71], v[64:67], v[32:35]
  v_mfma_f32_16x16x32_bf16 v[36:39], v[72:75], v[64:67], v[36:39]
  v_perm_b32 v68, v166, v162, s60
  v_perm_b32 v69, v174, v170, s60
  v_perm_b32 v70, v182, v178, s60
  v_perm_b32 v71, v190, v186, s60
  v_perm_b32 v72, v166, v162, s61
  v_perm_b32 v73, v174, v170, s61
  v_perm_b32 v74, v182, v178, s61
  v_perm_b32 v75, v190, v186, s61
  v_mfma_f32_16x16x32_bf16 v[40:43], v[76:79], v[64:67], v[40:43]
  v_mfma_f32_16x16x32_bf16 v[44:47], v[80:83], v[64:67], v[44:47]
  v_perm_b32 v76, v167, v163, s60
  v_perm_b32 v77, v175, v171, s60
  v_perm_b32 v78, v183, v179, s60
  v_perm_b32 v79, v191, v187, s60
  v_perm_b32 v80, v167, v163, s61
  v_perm_b32 v81, v175, v171, s61
  v_perm_b32 v82, v183, v179, s61
  v_perm_b32 v83, v191, v187, s61
  v_mfma_f32_16x16x32_bf16 v[48:51], v[68:71], v[64:67], v[48:51]
  v_mfma_f32_16x16x32_bf16 v[52:55], v[72:75], v[64:67], v[52:55]
  v_mfma_f32_16x16x32_bf16 v[56:59], v[76:79], v[64:67], v[56:59]
  v_mfma_f32_16x16x32_bf16 v[60:63], v[80:83], v[64:67], v[60:63]
L_s2:
  s_and_b32 s76, s50, 3
  s_lshr_b32 s50, s50, 2
  s_cmp_eq_u32 s76, 0
  s_cbranch_scc1 L_w2
  s_cmp_eq_u32 s76, 2
  s_cbranch_scc1 L_vf2
L_vp2:
  s_set_gpr_idx_on s45, gpr_idx(SRC0)
  s_nop 0
  v_mov_b32 v89, v96
  s_set_gpr_idx_off
  s_add_u32 s45, s45, 1
  v_lshlrev_b32 v90, 16, v89
  v_and_b32 v91, s62, v89
  v_fma_f32 v90, v90, s63, -v85
  v_fma_f32 v91, v91, s63, -v85
  v_exp_f32 v90, v90
  v_exp_f32 v91, v91
  s_cmp_eq_u32 s50, 3
  v_add_f32 v86, v86, v90
  v_cvt_pk_bf16_f32 v64, v90, v91
  v_add_f32 v86, v86, v91
  s_nop 0
  v_mov_b32_dpp v65, v64 row_shl:4 row_mask:0xf bank_mask:0xf bound_ctrl:0
  v_mov_b32_dpp v66, v64 row_shl:8 row_mask:0xf bank_mask:0xf bound_ctrl:0
  v_mov_b32_dpp v67, v64 row_shl:12 row_mask:0xf bank_mask:0xf bound_ctrl:0
  s_cbranch_scc1 L_last2
L_w2:
  s_waitcnt vmcnt(8)
  s_mov_b32 s9, 2
  s_cmp_lt_u32 s72, s73
  s_cbranch_scc0 L_nb
  s_lshl2_add_u32 s50, s51, s50
L_hv2:
  s_and_b32 s66, s72, 3
  s_lshl_b32 s66, s66, 22
  s_lshr_b32 s67, s72, 2
  s_lshl_b32 s67, s67, 17
  s_add_u32 s66, s66, s67
  s_add_u32 s70, s66, s49
  s_add_u32 s72, s72, 1
  s_cmp_lg_u32 s51, 0
  s_cbranch_scc1 L_iv2
  s_cmp_lt_u32 s52, 6
  s_cbranch_scc1 L_ld2
  buffer_load_dwordx4 v[128:131], v4, s[32:35], s70 offen offset:0 nt
  buffer_load_dwordx4 v[132:135], v4, s[32:35], s70 offen offset:128 nt
  buffer_load_dwordx4 v[136:139], v4, s[32:35], s70 offen offset:2048 nt
  buffer_load_dwordx4 v[140:143], v4, s[32:35], s70 offen offset:2176 nt
  buffer_load_dwordx4 v[144:147], v5, s[32:35], s70 offen offset:0 nt
  buffer_load_dwordx4 v[148:151], v5, s[32:35], s70 offen offset:128 nt
  buffer_load_dwordx4 v[152:155], v5, s[32:35], s70 offen offset:2048 nt
  buffer_load_dwordx4 v[156:159], v5, s[32:35], s70 offen offset:2176 nt
  s_cmp_lg_u32 s47, 1
  s_cbranch_scc1 L_go2
  s_add_u32 s66, s72, 1
  s_cmp_lt_u32 s66, s73
  s_cbranch_scc1 L_go2
  s_mov_b32 s47, 3
  s_branch L_rq2
L_iv2:
  buffer_load_dwordx4 v[128:131], v6, s[36:39], s70 offen offset:0 nt
  buffer_load_dwordx4 v[132:135], v6, s[36:39], s70 offen offset:1024 nt
  buffer_load_dwordx4 v[136:139], v6, s[36:39], s70 offen offset:2048 nt
  buffer_load_dwordx4 v[140:143], v6, s[36:39], s70 offen offset:3072 nt
  buffer_load_dwordx4 v[144:147], v7, s[36:39], s70 offen offset:0 nt
  buffer_load_dwordx4 v[148:151], v7, s[36:39], s70 offen offset:1024 nt
  buffer_load_dwordx4 v[152:155], v7, s[36:39], s70 offen offset:2048 nt
  buffer_load_dwordx4 v[156:159], v7, s[36:39], s70 offen offset:3072 nt
  s_cmp_lt_u32 s72, s73
  s_cbranch_scc1 L_go2
  s_cmp_lg_u32 s6, 0
  s_cbranch_scc1 L_go2
  s_cmp_lt_u32 s52, 6
  s_cbranch_scc1 L_go2
  s_cmp_ge_u32 s78, s48
  s_cselect_b32 s78, 0x400, s78
  s_cbranch_scc1 L_go2
L_rq2:
  s_mov_b32 s78, 1
  s_atomic_add s78, s[28:29], s69 glc
L_go2:
  s_cmp_lg_u32 s76, 0
  s_cbranch_scc1 L_pv2
  v_mfma_f32_16x16x32_bf16 v[16:19], v[192:195], v[8:11], 0
  v_mfma_f32_16x16x32_bf16 v[20:23], v[200:203], v[8:11], 0
  v_mfma_f32_16x16x32_bf16 v[24:27], v[208:211], v[8:11], 0
  v_mfma_f32_16x16x32_bf16 v[28:31], v[216:219], v[8:11], 0
  v_mfma_f32_16x16x32_bf16 v[16:19], v[196:199], v[12:15], v[16:19]
  v_mfma_f32_16x16x32_bf16 v[20:23], v[204:207], v[12:15], v[20:23]
  v_mfma_f32_16x16x32_bf16 v[24:27], v[212:215], v[12:15], v[24:27]
  v_mfma_f32_16x16x32_bf16 v[28:31], v[220:223], v[12:15], v[28:31]
  s_nop 4
  v_add_f32_dpp v87, v17, v16 row_shl:4 row_mask:0xf bank_mask:0x1
  v_add_f32_dpp v88, v19, v18 row_shl:4 row_mask:0xf bank_mask:0x1
  s_nop 0
  v_add_f32_dpp v87, v20, v21 row_shr:4 row_mask:0xf bank_mask:0x2
  v_add_f32_dpp v88, v22, v23 row_shr:4 row_mask:0xf bank_mask:0x2
  s_nop 0
  v_add_f32_dpp v87, v25, v24 row_shl:4 row_mask:0xf bank_mask:0x4
  v_add_f32_dpp v88, v27, v26 row_shl:4 row_mask:0xf bank_mask:0x4
  s_nop 0
  v_add_f32_dpp v87, v28, v29 row_shr:4 row_mask:0xf bank_mask:0x8
  v_add_f32_dpp v88, v30, v31 row_shr:4 row_mask:0xf bank_mask:0x8
  v_cvt_pk_bf16_f32 v89, v87, v88
  v_lshlrev_b32 v90, 16, v89
  v_and_b32 v91, s62, v89
  v_mul_f32 v90, 0x3db504f3, v90
  v_mul_f32 v91, 0x3db504f3, v91
  v_cvt_pk_bf16_f32 v89, v90, v91
  s_set_gpr_idx_on s44, gpr_idx(DST)
  s_nop 0
  v_mov_b32 v96, v89
  s_set_gpr_idx_off
  s_add_u32 s44, s44, 1
  v_lshlrev_b32 v90, 16, v89
  v_and_b32 v91, s62, v89
  v_max3_f32 v93, v90, v91, v93
  s_branch L_s3
L_pv2:
  v_perm_b32 v68, v196, v192, s60
  v_perm_b32 v69, v204, v200, s60
  v_perm_b32 v70, v212, v208, s60
  v_perm_b32 v71, v220, v216, s60
  v_perm_b32 v72, v196, v192, s61
  v_perm_b32 v73, v204, v200, s61
  v_perm_b32 v74, v212, v208, s61
  v_perm_b32 v75, v220, v216, s61
  v_perm_b32 v76, v197, v193, s60
  v_perm_b32 v77, v205, v201, s60
  v_perm_b32 v78, v213, v209, s60
  v_perm_b32 v79, v221, v217, s60
  v_perm_b32 v80, v197, v193, s61
  v_perm_b32 v81, v205, v201, s61
  v_perm_b32 v82, v213, v209, s61
  v_perm_b32 v83, v221, v217, s61
  v_mfma_f32_16x16x32_bf16 v[32:35], v[68:71], v[64:67], v[32:35]
  v_mfma_f32_16x16x32_bf16 v[36:39], v[72:75], v[64:67], v[36:39]
  v_perm_b32 v68, v198, v194, s60
  v_perm_b32 v69, v206, v202, s60
  v_perm_b32 v70, v214, v210, s60
  v_perm_b32 v71, v222, v218, s60
  v_perm_b32 v72, v198, v194, s61
  v_perm_b32 v73, v206, v202, s61
  v_perm_b32 v74, v214, v210, s61
  v_perm_b32 v75, v222, v218, s61
  v_mfma_f32_16x16x32_bf16 v[40:43], v[76:79], v[64:67], v[40:43]
  v_mfma_f32_16x16x32_bf16 v[44:47], v[80:83], v[64:67], v[44:47]
  v_perm_b32 v76, v199, v195, s60
  v_perm_b32 v77, v207, v203, s60
  v_perm_b32 v78, v215, v211, s60
  v_perm_b32 v79, v223, v219, s60
  v_perm_b32 v80, v199, v195, s61
  v_perm_b32 v81, v207, v203, s61
  v_perm_b32 v82, v215, v211, s61
  v_perm_b32 v83, v223, v219, s61
  v_mfma_f32_16x16x32_bf16 v[48:51], v[68:71], v[64:67], v[48:51]
  v_mfma_f32_16x16x32_bf16 v[52:55], v[72:75], v[64:67], v[52:55]
  v_mfma_f32_16x16x32_bf16 v[56:59], v[76:79], v[64:67], v[56:59]
  v_mfma_f32_16x16x32_bf16 v[60:63], v[80:83], v[64:67], v[60:63]
L_s3:
  s_and_b32 s76, s50, 3
  s_lshr_b32 s50, s50, 2
  s_cmp_eq_u32 s76, 0
  s_cbranch_scc1 L_w3
  s_cmp_eq_u32 s76, 2
  s_cbranch_scc1 L_vf3
L_vp3:
  s_set_gpr_idx_on s45, gpr_idx(SRC0)
  s_nop 0
  v_mov_b32 v89, v96
  s_set_gpr_idx_off
  s_add_u32 s45, s45, 1
  v_lshlrev_b32 v90, 16, v89
  v_and_b32 v91, s62, v89
  v_fma_f32 v90, v90, s63, -v85
  v_fma_f32 v91, v91, s63, -v85
  v_exp_f32 v90, v90
  v_exp_f32 v91, v91
  s_cmp_eq_u32 s50, 3
  v_add_f32 v86, v86, v90
  v_cvt_pk_bf16_f32 v64, v90, v91
  v_add_f32 v86, v86, v91
  s_nop 0
  v_mov_b32_dpp v65, v64 row_shl:4 row_mask:0xf bank_mask:0xf bound_ctrl:0
  v_mov_b32_dpp v66, v64 row_shl:8 row_mask:0xf bank_mask:0xf bound_ctrl:0
  v_mov_b32_dpp v67, v64 row_shl:12 row_mask:0xf bank_mask:0xf bound_ctrl:0
  s_cbranch_scc1 L_last3
L_w3:
  s_waitcnt vmcnt(8)
  s_mov_b32 s9, 3
  s_cmp_lt_u32 s72, s73
  s_cbranch_scc0 L_nb
  s_lshl2_add_u32 s50, s51, s50
L_hv3:
  s_and_b32 s66, s72, 3
  s_lshl_b32 s66, s66, 22
  s_lshr_b32 s67, s72, 2
  s_lshl_b32 s67, s67, 17
  s_add_u32 s66, s66, s67
  s_add_u32 s70, s66, s49
  s_add_u32 s72, s72, 1
  s_cmp_lg_u32 s51, 0
  s_cbranch_scc1 L_iv3
  s_cmp_lt_u32 s52, 6
  s_cbranch_scc1 L_ld3
  buffer_load_dwordx4 v[160:163], v4, s[32:35], s70 offen offset:0 nt
  buffer_load_dwordx4 v[164:167], v4, s[32:35], s70 offen offset:128 nt
  buffer_load_dwordx4 v[168:171], v4, s[32:35], s70 offen offset:2048 nt
  buffer_load_dwordx4 v[172:175], v4, s[32:35], s70 offen offset:2176 nt
  buffer_load_dwordx4 v[176:179], v5, s[32:35], s70 offen offset:0 nt
  buffer_load_dwordx4 v[180:183], v5, s[32:35], s70 offen offset:128 nt
  buffer_load_dwordx4 v[184:187], v5, s[32:35], s70 offen offset:2048 nt
  buffer_load_dwordx4 v[188:191], v5, s[32:35], s70 offen offset:2176 nt
  s_cmp_lg_u32 s47, 1
  s_cbranch_scc1 L_go3
  s_add_u32 s66, s72, 1
  s_cmp_lt_u32 s66, s73
  s_cbranch_scc1 L_go3
  s_mov_b32 s47, 3
  s_branch L_rq3
L_iv3:
  buffer_load_dwordx4 v[160:163], v6, s[36:39], s70 offen offset:0 nt
  buffer_load_dwordx4 v[164:167], v6, s[36:39], s70 offen offset:1024 nt
  buffer_load_dwordx4 v[168:171], v6, s[36:39], s70 offen offset:2048 nt
  buffer_load_dwordx4 v[172:175], v6, s[36:39], s70 offen offset:3072 nt
  buffer_load_dwordx4 v[176:179], v7, s[36:39], s70 offen offset:0 nt
  buffer_load_dwordx4 v[180:183], v7, s[36:39], s70 offen offset:1024 nt
  buffer_load_dwordx4 v[184:187], v7, s[36:39], s70 offen offset:2048 nt
  buffer_load_dwordx4 v[188:191], v7, s[36:39], s70 offen offset:3072 nt
  s_cmp_lt_u32 s72, s73
  s_cbranch_scc1 L_go3
  s_cmp_lg_u32 s6, 0
  s_cbranch_scc1 L_go3
  s_cmp_lt_u32 s52, 6
  s_cbranch_scc1 L_go3
  s_cmp_ge_u32 s78, s48
  s_cselect_b32 s78, 0x400, s78
  s_cbranch_scc1 L_go3
L_rq3:
  s_mov_b32 s78, 1
  s_atomic_add s78, s[28:29], s69 glc
L_go3:
  s_cmp_lg_u32 s76, 0
  s_cbranch_scc1 L_pv3
  v_mfma_f32_16x16x32_bf16 v[16:19], v[224:227], v[8:11], 0
  v_mfma_f32_16x16x32_bf16 v[20:23], v[232:235], v[8:11], 0
  v_mfma_f32_16x16x32_bf16 v[24:27], v[240:243], v[8:11], 0
  v_mfma_f32_16x16x32_bf16 v[28:31], v[248:251], v[8:11], 0
  v_mfma_f32_16x16x32_bf16 v[16:19], v[228:231], v[12:15], v[16:19]
  v_mfma_f32_16x16x32_bf16 v[20:23], v[236:239], v[12:15], v[20:23]
  v_mfma_f32_16x16x32_bf16 v[24:27], v[244:247], v[12:15], v[24:27]
  v_mfma_f32_16x16x32_bf16 v[28:31], v[252:255], v[12:15], v[28:31]
  s_nop 4
  v_add_f32_dpp v87, v17, v16 row_shl:4 row_mask:0xf bank_mask:0x1
  v_add_f32_dpp v88, v19, v18 row_shl:4 row_mask:0xf bank_mask:0x1
  s_nop 0
  v_add_f32_dpp v87, v20, v21 row_shr:4 row_mask:0xf bank_mask:0x2
  v_add_f32_dpp v88, v22, v23 row_shr:4 row_mask:0xf bank_mask:0x2
  s_nop 0
  v_add_f32_dpp v87, v25, v24 row_shl:4 row_mask:0xf bank_mask:0x4
  v_add_f32_dpp v88, v27, v26 row_shl:4 row_mask:0xf bank_mask:0x4
  s_nop 0
  v_add_f32_dpp v87, v28, v29 row_shr:4 row_mask:0xf bank_mask:0x8
  v_add_f32_dpp v88, v30, v31 row_shr:4 row_mask:0xf bank_mask:0x8
  v_cvt_pk_bf16_f32 v89, v87, v88
  v_lshlrev_b32 v90, 16, v89
  v_and_b32 v91, s62, v89
  v_mul_f32 v90, 0x3db504f3, v90
  v_mul_f32 v91, 0x3db504f3, v91
  v_cvt_pk_bf16_f32 v89, v90, v91
  s_set_gpr_idx_on s44, gpr_idx(DST)
  s_nop 0
  v_mov_b32 v96, v89
  s_set_gpr_idx_off
  s_add_u32 s44, s44, 1
  v_lshlrev_b32 v90, 16, v89
  v_and_b32 v91, s62, v89
  v_max3_f32 v93, v90, v91, v93
  s_branch L_s0
L_pv3:
  v_perm_b32 v68, v228, v224, s60
  v_perm_b32 v69, v236, v232, s60
  v_perm_b32 v70, v244, v240, s60
  v_perm_b32 v71, v252, v248, s60
  v_perm_b32 v72, v228, v224, s61
  v_perm_b32 v73, v236, v232, s61
  v_perm_b32 v74, v244, v240, s61
  v_perm_b32 v75, v252, v248, s61
  v_perm_b32 v76, v229, v225, s60
  v_perm_b32 v77, v237, v233, s60
  v_perm_b32 v78, v245, v241, s60
  v_perm_b32 v79, v253, v249, s60
  v_perm_b32 v80, v229, v225, s61
  v_perm_b32 v81, v237, v233, s61
  v_perm_b32 v82, v245, v241, s61
  v_perm_b32 v83, v253, v249, s61
  v_mfma_f32_16x16x32_bf16 v[32:35], v[68:71], v[64:67], v[32:35]
  v_mfma_f32_16x16x32_bf16 v[36:39], v[72:75], v[64:67], v[36:39]
  v_perm_b32 v68, v230, v226, s60
  v_perm_b32 v69, v238, v234, s60
  v_perm_b32 v70, v246, v242, s60
  v_perm_b32 v71, v254, v250, s60
  v_perm_b32 v72, v230, v226, s61
  v_perm_b32 v73, v238, v234, s61
  v_perm_b32 v74, v246, v242, s61
  v_perm_b32 v75, v254, v250, s61
  v_mfma_f32_16x16x32_bf16 v[40:43], v[76:79], v[64:67], v[40:43]
  v_mfma_f32_16x16x32_bf16 v[44:47], v[80:83], v[64:67], v[44:47]
  v_perm_b32 v76, v231, v227, s60
  v_perm_b32 v77, v239, v235, s60
  v_perm_b32 v78, v247, v243, s60
  v_perm_b32 v79, v255, v251, s60
  v_perm_b32 v80, v231, v227, s61
  v_perm_b32 v81, v239, v235, s61
  v_perm_b32 v82, v247, v243, s61
  v_perm_b32 v83, v255, v251, s61
  v_mfma_f32_16x16x32_bf16 v[48:51], v[68:71], v[64:67], v[48:51]
  v_mfma_f32_16x16x32_bf16 v[52:55], v[72:75], v[64:67], v[52:55]
  v_mfma_f32_16x16x32_bf16 v[56:59], v[76:79], v[64:67], v[56:59]
  v_mfma_f32_16x16x32_bf16 v[60:63], v[80:83], v[64:67], v[60:63]
  s_branch L_s0
L_loop_end:
L_ld0:
  ds_read_b128 v[192:195], v127 offset:0
  ds_read_b128 v[196:199], v127 offset:1024
  ds_read_b128 v[200:203], v127 offset:2048
  ds_read_b128 v[204:207], v127 offset:3072
  ds_read_b128 v[208:211], v127 offset:4096
  ds_read_b128 v[212:215], v127 offset:5120
  ds_read_b128 v[216:219], v127 offset:6144
  ds_read_b128 v[220:223], v127 offset:7168
  v_add_u32 v127, 0x2000, v127
  s_waitcnt lgkmcnt(0)
  s_branch L_go0
L_ld1:
  ds_read_b128 v[224:227], v127 offset:0
  ds_read_b128 v[228:231], v127 offset:1024
  ds_read_b128 v[232:235], v127 offset:2048
  ds_read_b128 v[236:239], v127 offset:3072
  ds_read_b128 v[240:243], v127 offset:4096
  ds_read_b128 v[244:247], v127 offset:5120
  ds_read_b128 v[248:251], v127 offset:6144
  ds_read_b128 v[252:255], v127 offset:7168
  v_add_u32 v127, 0x2000, v127
  s_waitcnt lgkmcnt(0)
  s_branch L_go1
L_ld2:
  ds_read_b128 v[128:131], v127 offset:0
  ds_read_b128 v[132:135], v127 offset:1024
  ds_read_b128 v[136:139], v127 offset:2048
  ds_read_b128 v[140:143], v127 offset:3072
  ds_read_b128 v[144:147], v127 offset:4096
  ds_read_b128 v[148:151], v127 offset:5120
  ds_read_b128 v[152:155], v127 offset:6144
  ds_read_b128 v[156:159], v127 offset:7168
  v_add_u32 v127, 0x2000, v127
  s_waitcnt lgkmcnt(0)
  s_branch L_go2
L_ld3:
  ds_read_b128 v[160:163], v127 offset:0
  ds_read_b128 v[164:167], v127 offset:1024
  ds_read_b128 v[168:171], v127 offset:2048
  ds_read_b128 v[172:175], v127 offset:3072
  ds_read_b128 v[176:179], v127 offset:4096
  ds_read_b128 v[180:183], v127 offset:5120
  ds_read_b128 v[184:187], v127 offset:6144
  ds_read_b128 v[188:191], v127 offset:7168
  v_add_u32 v127, 0x2000, v127
  s_waitcnt lgkmcnt(0)
  s_branch L_go3
L_T3:
  s_mov_b64 s[40:41], s[30:31]
  s_mov_b32 s42, 2097152
  s_mov_b32 s43, 0x20000
  s_mov_b32 s60, 0x05040100
  s_mov_b32 s61, 0x07060302
  s_mov_b32 s62, 0xffff0000
  s_mov_b32 s63, 0x3fb8aa3b
  s_mov_b32 s64, 0xff
  s_mov_b32 s65, 1600000
  s_lshr_b32 s54, s53, 3
  s_add_u32 s54, s54, s3
  s_and_b32 s54, s54, 3
  s_add_u32 s55, s53, s3
  s_and_b32 s55, s55, 7
  s_lshl_b32 s67, s55, 2
  s_add_u32 s54, s54, s67
  s_waitcnt lgkmcnt(0)
  s_add_u32 s56, s56, 1
  s_and_b32 s56, s56, 0xff
  s_add_u32 s57, s56, 37
  s_and_b32 s57, s57, 0xff
  s_add_u32 s58, s56, 74
  s_and_b32 s58, s58, 0xff
  s_add_u32 s59, s56, 111
  s_and_b32 s59, s59, 0xff
  v_mov_b32 v4, s56
  v_mov_b32 v5, s57
  v_mov_b32 v6, s58
  v_mov_b32 v7, s59
  v_mov_b32 v17, 0
  v_mov_b32 v18, 1
  s_mov_b64 exec, 1
  ds_add_u32 v17, v18 offset:1288
  s_mov_b64 exec, -1
  v_and_b32 v8, 3, v1
  v_mul_u32_u24 v8, 37, v8
  v_add_u32 v8, s56, v8
  v_and_b32 v8, 0xff, v8
  s_cmp_eq_u32 s77, 0
  s_cbranch_scc1 L_svc
  s_cmp_eq_u32 s77, 2
  s_cbranch_scc1 L_jobQ
L_jobM:
  s_waitcnt vmcnt(8)
  v_lshlrev_b32 v26, 16, v24
  v_and_b32 v27, s62, v24
  v_mul_f32 v28, 0xbfb8aa3b, v26
  v_mul_f32 v29, 0xbfb8aa3b, v27
  v_exp_f32 v28, v28
  v_exp_f32 v29, v29
  v_add_f32 v28, 1.0, v28
  v_add_f32 v29, 1.0, v29
  v_rcp_f32 v28, v28
  v_rcp_f32 v29, v29
  v_mul_f32 v26, v26, v28
  v_mul_f32 v27, v27, v29
  v_cvt_pk_bf16_f32 v24, v26, v27
  s_nop 1
  v_mov_b32_dpp v25, v24 row_shl:4 row_mask:0xf bank_mask:0xf bound_ctrl:0
  v_mov_b32_dpp v26, v24 row_shl:8 row_mask:0xf bank_mask:0xf bound_ctrl:0
  v_mov_b32_dpp v27, v24 row_shl:12 row_mask:0xf bank_mask:0xf bound_ctrl:0
  s_lshl_b32 s66, s52, 7
  v_lshl_add_u32 v16, v1, 5, s66
  s_lshl_b32 s76, s75, 7
  s_add_u32 s76, s76, 16384
  s_waitcnt vmcnt(0)
  v_perm_b32 v64, v36, v32, s60
  v_perm_b32 v65, v44, v40, s60
  v_perm_b32 v66, v52, v48, s60
  v_perm_b32 v67, v60, v56, s60
  v_perm_b32 v68, v36, v32, s61
  v_perm_b32 v69, v44, v40, s61
  v_perm_b32 v70, v52, v48, s61
  v_perm_b32 v71, v60, v56, s61
  v_perm_b32 v72, v37, v33, s60
  v_perm_b32 v73, v45, v41, s60
  v_perm_b32 v74, v53, v49, s60
  v_perm_b32 v75, v61, v57, s60
  v_perm_b32 v76, v37, v33, s61
  v_perm_b32 v77, v45, v41, s61
  v_perm_b32 v78, v53, v49, s61
  v_perm_b32 v79, v61, v57, s61
  v_perm_b32 v80, v38, v34, s60
  v_perm_b32 v81, v46, v42, s60
  v_perm_b32 v82, v54, v50, s60
  v_perm_b32 v83, v62, v58, s60
  v_perm_b32 v84, v38, v34, s61
  v_perm_b32 v85, v46, v42, s61
  v_perm_b32 v86, v54, v50, s61
  v_perm_b32 v87, v62, v58, s61
  v_perm_b32 v88, v39, v35, s60
  v_perm_b32 v89, v47, v43, s60
  v_perm_b32 v90, v55, v51, s60
  v_perm_b32 v91, v63, v59, s60
  v_perm_b32 v92, v39, v35, s61
  v_perm_b32 v93, v47, v43, s61
  v_perm_b32 v94, v55, v51, s61
  v_perm_b32 v95, v63, v59, s61
  v_mfma_f32_16x16x32_bf16 v[32:35], v[24:27], v[64:67], 0
  v_mfma_f32_16x16x32_bf16 v[36:39], v[24:27], v[68:71], 0
  v_mfma_f32_16x16x32_bf16 v[40:43], v[24:27], v[72:75], 0
  v_mfma_f32_16x16x32_bf16 v[44:47], v[24:27], v[76:79], 0
  v_mfma_f32_16x16x32_bf16 v[48:51], v[24:27], v[80:83], 0
  v_mfma_f32_16x16x32_bf16 v[52:55], v[24:27], v[84:87], 0
  v_mfma_f32_16x16x32_bf16 v[56:59], v[24:27], v[88:91], 0
  v_mfma_f32_16x16x32_bf16 v[60:63], v[24:27], v[92:95], 0
  s_nop 0
  v_add_f32_dpp v96, v33, v32 row_shl:4 row_mask:0xf bank_mask:0xf bound_ctrl:0
  v_add_f32_dpp v97, v37, v36 row_shl:4 row_mask:0xf bank_mask:0xf bound_ctrl:0
  v_add_f32_dpp v98, v41, v40 row_shl:4 row_mask:0xf bank_mask:0xf bound_ctrl:0
  v_add_f32_dpp v99, v45, v44 row_shl:4 row_mask:0xf bank_mask:0xf bound_ctrl:0
  v_add_f32_dpp v100, v49, v48 row_shl:4 row_mask:0xf bank_mask:0xf bound_ctrl:0
  v_add_f32_dpp v101, v53, v52 row_shl:4 row_mask:0xf bank_mask:0xf bound_ctrl:0
  v_add_f32_dpp v102, v57, v56 row_shl:4 row_mask:0xf bank_mask:0xf bound_ctrl:0
  v_add_f32_dpp v103, v61, v60 row_shl:4 row_mask:0xf bank_mask:0xf bound_ctrl:0
  v_add_f32_dpp v96, v34, v96 row_shl:8 row_mask:0xf bank_mask:0xf bound_ctrl:0
  v_add_f32_dpp v97, v38, v97 row_shl:8 row_mask:0xf bank_mask:0xf bound_ctrl:0
  v_add_f32_dpp v98, v42, v98 row_shl:8 row_mask:0xf bank_mask:0xf bound_ctrl:0
  v_add_f32_dpp v99, v46, v99 row_shl:8 row_mask:0xf bank_mask:0xf bound_ctrl:0
  v_add_f32_dpp v100, v50, v100 row_shl:8 row_mask:0xf bank_mask:0xf bound_ctrl:0
  v_add_f32_dpp v101, v54, v101 row_shl:8 row_mask:0xf bank_mask:0xf bound_ctrl:0
  v_add_f32_dpp v102, v58, v102 row_shl:8 row_mask:0xf bank_mask:0xf bound_ctrl:0
  v_add_f32_dpp v103, v62, v103 row_shl:8 row_mask:0xf bank_mask:0xf bound_ctrl:0
  v_add_f32_dpp v96, v35, v96 row_shl:12 row_mask:0xf bank_mask:0xf bound_ctrl:0
  v_add_f32_dpp v97, v39, v97 row_shl:12 row_mask:0xf bank_mask:0xf bound_ctrl:0
  v_add_f32_dpp v98, v43, v98 row_shl:12 row_mask:0xf bank_mask:0xf bound_ctrl:0
  v_add_f32_dpp v99, v47, v99 row_shl:12 row_mask:0xf bank_mask:0xf bound_ctrl:0
  v_add_f32_dpp v100, v51, v100 row_shl:12 row_mask:0xf bank_mask:0xf bound_ctrl:0
  v_add_f32_dpp v101, v55, v101 row_shl:12 row_mask:0xf bank_mask:0xf bound_ctrl:0
  v_add_f32_dpp v102, v59, v102 row_shl:12 row_mask:0xf bank_mask:0xf bound_ctrl:0
  v_add_f32_dpp v103, v63, v103 row_shl:12 row_mask:0xf bank_mask:0xf bound_ctrl:0
  s_mov_b64 exec, 0xf
  ds_write_b128 v16, v[96:99] offset:2048
  ds_write_b128 v16, v[100:103] offset:2064
  s_mov_b64 exec, 1
  v_mov_b32 v17, 0
  v_mov_b32 v18, 1
  ds_add_u32 v17, v18 offset:1284
  s_mov_b64 exec, -1
  s_cmp_lg_u32 s52, 0
  s_cbranch_scc1 L_svc
  v_lshlrev_b32 v16, 2, v1
  v_add_u32 v18, 2048, v16
  v_mov_b32 v17, 0
L_mspin:
  ds_read_b32 v19, v17 offset:1284
  ds_read2_b32 v[20:21], v18 offset0:0 offset1:32
  ds_read2_b32 v[22:23], v18 offset0:64 offset1:96
  s_sub_u32 s65, s65, 1
  s_cbranch_scc1 L_fin
  s_waitcnt lgkmcnt(0)
  v_cmp_ne_u32 vcc, 4, v19
  s_cbranch_vccnz L_mspin
  s_mov_b32 exec_hi, 0
  s_branch L_mqpub
L_jobQ:
  s_cmp_lg_u32 s52, 0
  s_cbranch_scc1 L_noinit
  s_and_b32 s66, s75, 7
  s_cmp_lg_u32 s66, 0
  s_cbranch_scc1 L_noinit
  s_lshr_b32 s66, s75, 3
  s_mul_i32 s66, s66, 8192
  s_add_u32 s66, s66, 131072
  v_mul_u32_u24 v16, 1024, v1
  v_mov_b32 v17, 0
  s_mov_b64 exec, 0xff
  buffer_store_dword v17, v16, s[40:43], s66 offen sc1
  s_mov_b64 exec, -1
  s_waitcnt vmcnt(17)
  s_branch L_init2
L_noinit:
  s_waitcnt vmcnt(16)
L_init2:
  v_lshlrev_b32 v32, 16, v20
  v_and_b32 v33, s62, v20
  v_lshlrev_b32 v34, 16, v21
  v_and_b32 v35, s62, v21
  v_lshlrev_b32 v36, 16, v22
  v_and_b32 v37, s62, v22
  v_lshlrev_b32 v38, 16, v23
  v_and_b32 v39, s62, v23
  v_pk_add_f32 v[40:41], v[32:33], v[36:37]
  v_pk_add_f32 v[42:43], v[34:35], v[38:39]
  v_pk_add_f32 v[40:41], v[40:41], v[42:43]
  v_add_f32 v28, v40, v41
  s_nop 1
  v_add_f32_dpp v28, v28, v28 row_ror:8 row_mask:0xf bank_mask:0xf
  s_nop 1
  v_add_f32_dpp v28, v28, v28 row_ror:4 row_mask:0xf bank_mask:0xf
  s_nop 1
  v_add_f32_dpp v28, v28, v28 row_ror:2 row_mask:0xf bank_mask:0xf
  s_nop 1
  v_add_f32_dpp v28, v28, v28 row_ror:1 row_mask:0xf bank_mask:0xf
  v_mov_b32 v40, v28
  s_nop 1
  v_permlane16_swap_b32 v28, v40
  v_add_f32 v28, v28, v40
  v_mov_b32 v40, v28
  s_nop 1
  v_permlane32_swap_b32 v28, v40
  v_add_f32 v28, v28, v40
  v_mul_f32 v28, 0x3b000000, v28
  v_sub_f32 v32, v32, v28
  v_sub_f32 v33, v33, v28
  v_sub_f32 v34, v34, v28
  v_sub_f32 v35, v35, v28
  v_sub_f32 v36, v36, v28
  v_sub_f32 v37, v37, v28
  v_sub_f32 v38, v38, v28
  v_sub_f32 v39, v39, v28
  v_pk_mul_f32 v[32:33], v[32:33], v[32:33]
  v_pk_mul_f32 v[34:35], v[34:35], v[34:35]
  v_pk_mul_f32 v[36:37], v[36:37], v[36:37]
  v_pk_mul_f32 v[38:39], v[38:39], v[38:39]
  v_pk_add_f32 v[40:41], v[32:33], v[36:37]
  v_pk_add_f32 v[42:43], v[34:35], v[38:39]
  v_pk_add_f32 v[40:41], v[40:41], v[42:43]
  v_add_f32 v30, v40, v41
  s_nop 1
  v_add_f32_dpp v30, v30, v30 row_ror:8 row_mask:0xf bank_mask:0xf
  s_nop 1
  v_add_f32_dpp v30, v30, v30 row_ror:4 row_mask:0xf bank_mask:0xf
  s_nop 1
  v_add_f32_dpp v30, v30, v30 row_ror:2 row_mask:0xf bank_mask:0xf
  s_nop 1
  v_add_f32_dpp v30, v30, v30 row_ror:1 row_mask:0xf bank_mask:0xf
  v_mov_b32 v40, v30
  s_nop 1
  v_permlane16_swap_b32 v30, v40
  v_add_f32 v30, v30, v40
  v_mov_b32 v40, v30
  s_nop 1
  v_permlane32_swap_b32 v30, v40
  v_add_f32 v30, v30, v40
  v_mul_f32 v30, 0x3b000000, v30
  v_cvt_pk_bf16_f32 v40, v28, v30
  v_lshlrev_b32 v28, 16, v40
  v_and_b32 v30, s62, v40
  v_add_f32 v30, 0x3727c5ac, v30
  v_cvt_pk_bf16_f32 v30, v30, v30
  v_and_b32 v30, s62, v30
  v_sqrt_f32 v30, v30
  s_nop 0
  v_cvt_pk_bf16_f32 v30, v30, v30
  v_and_b32 v30, s62, v30
  v_rcp_f32 v30, v30
  v_lshlrev_b32 v26, 16, v24
  v_and_b32 v27, s62, v24
  v_sub_f32 v26, v26, v28
  v_sub_f32 v27, v27, v28
  v_cvt_pk_bf16_f32 v40, v26, v27
  v_lshlrev_b32 v26, 16, v40
  v_and_b32 v27, s62, v40
  v_mul_f32 v26, v26, v30
  v_mul_f32 v27, v27, v30
  v_cvt_pk_bf16_f32 v40, v26, v27
  v_lshlrev_b32 v26, 16, v40
  v_and_b32 v27, s62, v40
  v_and_b32 v12, 1, v1
  v_mul_u32_u24 v12, 74, v12
  v_add_u32 v12, s56, v12
  v_add_u32 v13, 37, v12
  v_lshlrev_b32 v11, 1, v10
  s_mov_b32 s66, 16384
  s_lshl_b32 s76, s75, 8
  s_add_u32 s76, s76, 32768
  s_lshl_b32 s67, s52, 8
  v_lshl_add_u32 v16, v1, 5, s67
  s_waitcnt vmcnt(0)
  v_perm_b32 v192, v132, v128, s60
  v_perm_b32 v193, v140, v136, s60
  v_perm_b32 v194, v148, v144, s60
  v_perm_b32 v195, v156, v152, s60
  v_perm_b32 v196, v132, v128, s61
  v_perm_b32 v197, v140, v136, s61
  v_perm_b32 v198, v148, v144, s61
  v_perm_b32 v199, v156, v152, s61
  v_perm_b32 v200, v133, v129, s60
  v_perm_b32 v201, v141, v137, s60
  v_perm_b32 v202, v149, v145, s60
  v_perm_b32 v203, v157, v153, s60
  v_perm_b32 v204, v133, v129, s61
  v_perm_b32 v205, v141, v137, s61
  v_perm_b32 v206, v149, v145, s61
  v_perm_b32 v207, v157, v153, s61
  v_perm_b32 v208, v134, v130, s60
  v_perm_b32 v209, v142, v138, s60
  v_perm_b32 v210, v150, v146, s60
  v_perm_b32 v211, v158, v154, s60
  v_perm_b32 v212, v134, v130, s61
  v_perm_b32 v213, v142, v138, s61
  v_perm_b32 v214, v150, v146, s61
  v_perm_b32 v215, v158, v154, s61
  v_perm_b32 v216, v135, v131, s60
  v_perm_b32 v217, v143, v139, s60
  v_perm_b32 v218, v151, v147, s60
  v_perm_b32 v219, v159, v155, s60
  v_perm_b32 v220, v135, v131, s61
  v_perm_b32 v221, v143, v139, s61
  v_perm_b32 v222, v151, v147, s61
  v_perm_b32 v223, v159, v155, s61
  v_perm_b32 v224, v164, v160, s60
  v_perm_b32 v225, v172, v168, s60
  v_perm_b32 v226, v180, v176, s60
  v_perm_b32 v227, v188, v184, s60
  v_perm_b32 v228, v164, v160, s61
  v_perm_b32 v229, v172, v168, s61
  v_perm_b32 v230, v180, v176, s61
  v_perm_b32 v231, v188, v184, s61
  v_perm_b32 v232, v165, v161, s60
  v_perm_b32 v233, v173, v169, s60
  v_perm_b32 v234, v181, v177, s60
  v_perm_b32 v235, v189, v185, s60
  v_perm_b32 v236, v165, v161, s61
  v_perm_b32 v237, v173, v169, s61
  v_perm_b32 v238, v181, v177, s61
  v_perm_b32 v239, v189, v185, s61
  v_perm_b32 v240, v166, v162, s60
  v_perm_b32 v241, v174, v170, s60
  v_perm_b32 v242, v182, v178, s60
  v_perm_b32 v243, v190, v186, s60
  v_perm_b32 v244, v166, v162, s61
  v_perm_b32 v245, v174, v170, s61
  v_perm_b32 v246, v182, v178, s61
  v_perm_b32 v247, v190, v186, s61
  v_perm_b32 v248, v167, v163, s60
  v_perm_b32 v249, v175, v171, s60
  v_perm_b32 v250, v183, v179, s60
  v_perm_b32 v251, v191, v187, s60
  v_perm_b32 v252, v167, v163, s61
  v_perm_b32 v253, v175, v171, s61
  v_perm_b32 v254, v183, v179, s61
  v_perm_b32 v255, v191, v187, s61
  buffer_load_dwordx2 v[64:65], v11, s[40:43], s66 offen sc1
  buffer_load_dwordx2 v[66:67], v11, s[40:43], s66 offen offset:2048 sc1
  buffer_load_dwordx2 v[68:69], v11, s[40:43], s66 offen sc1
  buffer_load_dwordx2 v[70:71], v11, s[40:43], s66 offen offset:2048 sc1
  buffer_load_dwordx2 v[72:73], v11, s[40:43], s66 offen sc1
  buffer_load_dwordx2 v[74:75], v11, s[40:43], s66 offen offset:2048 sc1
L_pp_5:
  buffer_load_dwordx2 v[76:77], v11, s[40:43], s66 offen sc1
  buffer_load_dwordx2 v[78:79], v11, s[40:43], s66 offen offset:2048 sc1
  s_waitcnt vmcnt(6)
  v_mov_b32 v20, v64
  v_mov_b32 v21, v65
  v_mov_b32 v22, v66
  v_mov_b32 v23, v67
  v_xor_b32 v19, v12, v20
  v_bitop3_b32 v19, v19, v21, v13 bitop3:0xf6
  v_bitop3_b32 v19, v19, v22, v12 bitop3:0xf6
  v_bitop3_b32 v19, v19, v23, v13 bitop3:0xf6
  v_and_b32 v19, 0xff, v19
  v_cmp_ne_u32 vcc, 0, v19
  s_cbranch_vccz L_ppok_6
  buffer_load_dwordx2 v[64:65], v11, s[40:43], s66 offen sc1
  buffer_load_dwordx2 v[66:67], v11, s[40:43], s66 offen offset:2048 sc1
  s_waitcnt vmcnt(6)
  v_mov_b32 v20, v68
  v_mov_b32 v21, v69
  v_mov_b32 v22, v70
  v_mov_b32 v23, v71
  v_xor_b32 v19, v12, v20
  v_bitop3_b32 v19, v19, v21, v13 bitop3:0xf6
  v_bitop3_b32 v19, v19, v22, v12 bitop3:0xf6
  v_bitop3_b32 v19, v19, v23, v13 bitop3:0xf6
  v_and_b32 v19, 0xff, v19
  v_cmp_ne_u32 vcc, 0, v19
  s_cbranch_vccz L_ppok_6
  buffer_load_dwordx2 v[68:69], v11, s[40:43], s66 offen sc1
  buffer_load_dwordx2 v[70:71], v11, s[40:43], s66 offen offset:2048 sc1
  s_waitcnt vmcnt(6)
  v_mov_b32 v20, v72
  v_mov_b32 v21, v73
  v_mov_b32 v22, v74
  v_mov_b32 v23, v75
  v_xor_b32 v19, v12, v20
  v_bitop3_b32 v19, v19, v21, v13 bitop3:0xf6
  v_bitop3_b32 v19, v19, v22, v12 bitop3:0xf6
  v_bitop3_b32 v19, v19, v23, v13 bitop3:0xf6
  v_and_b32 v19, 0xff, v19
  v_cmp_ne_u32 vcc, 0, v19
  s_cbranch_vccz L_ppok_6
  buffer_load_dwordx2 v[72:73], v11, s[40:43], s66 offen sc1
  buffer_load_dwordx2 v[74:75], v11, s[40:43], s66 offen offset:2048 sc1
  s_waitcnt vmcnt(6)
  v_mov_b32 v20, v76
  v_mov_b32 v21, v77
  v_mov_b32 v22, v78
  v_mov_b32 v23, v79
  v_xor_b32 v19, v12, v20
  v_bitop3_b32 v19, v19, v21, v13 bitop3:0xf6
  v_bitop3_b32 v19, v19, v22, v12 bitop3:0xf6
  v_bitop3_b32 v19, v19, v23, v13 bitop3:0xf6
  v_and_b32 v19, 0xff, v19
  v_cmp_ne_u32 vcc, 0, v19
  s_cbranch_vccz L_ppok_6
  s_sub_u32 s65, s65, 1
  s_cbranch_scc1 L_fin
  s_branch L_pp_5
L_ppok_6:
  v_and_b32 v20, s62, v20
  v_and_b32 v21, s62, v21
  v_and_b32 v22, s62, v22
  v_and_b32 v23, s62, v23
  v_add_f32 v22, 1.0, v22
  v_add_f32 v23, 1.0, v23
  v_cvt_pk_bf16_f32 v19, v22, v23
  v_lshlrev_b32 v22, 16, v19
  v_and_b32 v23, s62, v19
  v_pk_mul_f32 v[26:27], v[26:27], v[22:23]
  v_cvt_pk_bf16_f32 v19, v26, v27
  v_lshlrev_b32 v26, 16, v19
  v_and_b32 v27, s62, v19
  v_pk_add_f32 v[26:27], v[26:27], v[20:21]
  v_cvt_pk_bf16_f32 v20, v26, v27
  s_nop 1
  v_mov_b32_dpp v21, v20 row_shl:4 row_mask:0xf bank_mask:0xf bound_ctrl:0
  v_mov_b32_dpp v22, v20 row_shl:8 row_mask:0xf bank_mask:0xf bound_ctrl:0
  v_mov_b32_dpp v23, v20 row_shl:12 row_mask:0xf bank_mask:0xf bound_ctrl:0
  s_nop 1
  v_mfma_f32_16x16x32_bf16 v[32:35], v[20:23], v[192:195], 0
  v_mov_b32_dpp v24, v20 row_shl:2 row_mask:0xf bank_mask:0xf bound_ctrl:0
  v_mfma_f32_16x16x32_bf16 v[36:39], v[20:23], v[196:199], 0
  v_mov_b32_dpp v25, v20 row_shl:6 row_mask:0xf bank_mask:0xf bound_ctrl:0
  v_mfma_f32_16x16x32_bf16 v[40:43], v[20:23], v[200:203], 0
  v_mov_b32_dpp v26, v20 row_shl:10 row_mask:0xf bank_mask:0xf bound_ctrl:0
  v_mfma_f32_16x16x32_bf16 v[44:47], v[20:23], v[204:207], 0
  v_mov_b32_dpp v27, v20 row_shl:14 row_mask:0xf bank_mask:0xf bound_ctrl:0
  v_mfma_f32_16x16x32_bf16 v[48:51], v[20:23], v[208:211], 0
  v_mfma_f32_16x16x32_bf16 v[52:55], v[20:23], v[212:215], 0
  v_mfma_f32_16x16x32_bf16 v[56:59], v[20:23], v[216:219], 0
  v_mfma_f32_16x16x32_bf16 v[60:63], v[20:23], v[220:223], 0
  v_mfma_f32_16x16x32_bf16 v[32:35], v[24:27], v[224:227], v[32:35]
  v_mfma_f32_16x16x32_bf16 v[36:39], v[24:27], v[228:231], v[36:39]
  v_mfma_f32_16x16x32_bf16 v[40:43], v[24:27], v[232:235], v[40:43]
  v_mfma_f32_16x16x32_bf16 v[44:47], v[24:27], v[236:239], v[44:47]
  v_mfma_f32_16x16x32_bf16 v[48:51], v[24:27], v[240:243], v[48:51]
  v_mfma_f32_16x16x32_bf16 v[52:55], v[24:27], v[244:247], v[52:55]
  v_mfma_f32_16x16x32_bf16 v[56:59], v[24:27], v[248:251], v[56:59]
  v_mfma_f32_16x16x32_bf16 v[60:63], v[24:27], v[252:255], v[60:63]
  s_nop 0
  v_add_f32_dpp v96, v33, v32 row_shl:8 row_mask:0xf bank_mask:0xf bound_ctrl:0
  v_add_f32_dpp v97, v37, v36 row_shl:8 row_mask:0xf bank_mask:0xf bound_ctrl:0
  v_add_f32_dpp v98, v41, v40 row_shl:8 row_mask:0xf bank_mask:0xf bound_ctrl:0
  v_add_f32_dpp v99, v45, v44 row_shl:8 row_mask:0xf bank_mask:0xf bound_ctrl:0
  v_add_f32_dpp v100, v49, v48 row_shl:8 row_mask:0xf bank_mask:0xf bound_ctrl:0
  v_add_f32_dpp v101, v53, v52 row_shl:8 row_mask:0xf bank_mask:0xf bound_ctrl:0
  v_add_f32_dpp v102, v57, v56 row_shl:8 row_mask:0xf bank_mask:0xf bound_ctrl:0
  v_add_f32_dpp v103, v61, v60 row_shl:8 row_mask:0xf bank_mask:0xf bound_ctrl:0
  s_mov_b64 exec, 0xff
  ds_write_b128 v16, v[96:99] offset:2048
  ds_write_b128 v16, v[100:103] offset:2064
  s_mov_b64 exec, 1
  v_mov_b32 v17, 0
  v_mov_b32 v18, 1
  ds_add_u32 v17, v18 offset:1284
  s_mov_b64 exec, -1
  s_cmp_lg_u32 s52, 0
  s_cbranch_scc1 L_svc
  v_lshlrev_b32 v16, 2, v1
  v_add_u32 v18, 2048, v16
  v_mov_b32 v17, 0
L_qjspin:
  ds_read_b32 v19, v17 offset:1284
  ds_read2st64_b32 v[20:21], v18 offset0:0 offset1:1
  ds_read2st64_b32 v[22:23], v18 offset0:2 offset1:3
  s_sub_u32 s65, s65, 1
  s_cbranch_scc1 L_fin
  s_waitcnt lgkmcnt(0)
  v_cmp_ne_u32 vcc, 4, v19
  s_cbranch_vccnz L_qjspin
L_mqpub:
  v_pk_add_f32 v[20:21], v[20:21], v[22:23]
  v_add_f32 v20, v20, v21
  v_cvt_pk_bf16_f32 v20, v20, v20
  v_and_or_b32 v20, v20, s62, v8
  buffer_store_dword v20, v16, s[40:43], s76 offen sc1
  s_mov_b64 exec, 1
  v_mov_b32 v18, 1
  ds_add_u32 v17, v18 offset:1284
  s_mov_b64 exec, -1
L_svc:
  s_cmp_eq_u32 s77, 3
  s_cbranch_scc1 L_tl
  s_cmp_eq_u32 s52, 0
  s_cbranch_scc1 L_svc0
  s_branch L_svc1
L_svc0:
  s_setprio 3
  v_lshlrev_b32 v18, 4, v1
  s_lshl_b32 s66, s55, 11
  s_add_u32 s66, s66, 32768
  v_lshlrev_b32 v17, 3, v1
  s_waitcnt vmcnt(0)
  s_add_u32 s68, s30, s66
  s_addc_u32 s69, s31, 0
  s_and_b32 s67, s53, 15
  s_lshl_b32 s67, s67, 7
L_h1:
  s_load_dword s70, s[68:69], s67 glc
  s_sub_u32 s65, s65, 1
  s_cbranch_scc1 L_fin
  s_waitcnt lgkmcnt(0)
  s_and_b32 s70, s70, 0xff
  s_cmp_eq_u32 s70, s56
  s_cbranch_scc1 L_h2
  s_sleep 2
  s_branch L_h1
L_h2:
  s_load_dword s32, s[68:69], 128 glc
  s_load_dword s33, s[68:69], 384 glc
  s_load_dword s34, s[68:69], 640 glc
  s_load_dword s35, s[68:69], 896 glc
  s_load_dword s36, s[68:69], 1152 glc
  s_load_dword s37, s[68:69], 1408 glc
  s_load_dword s38, s[68:69], 1664 glc
  s_load_dword s39, s[68:69], 1920 glc
  s_sub_u32 s65, s65, 1
  s_cbranch_scc1 L_fin
  s_waitcnt lgkmcnt(0)
  s_xor_b32 s67, s32, s56
  s_xor_b32 s33, s33, s56
  s_or_b32 s67, s67, s33
  s_xor_b32 s34, s34, s56
  s_or_b32 s67, s67, s34
  s_xor_b32 s35, s35, s56
  s_or_b32 s67, s67, s35
  s_xor_b32 s36, s36, s56
  s_or_b32 s67, s67, s36
  s_xor_b32 s37, s37, s56
  s_or_b32 s67, s67, s37
  s_xor_b32 s38, s38, s56
  s_or_b32 s67, s67, s38
  s_xor_b32 s39, s39, s56
  s_or_b32 s67, s67, s39
  s_and_b32 s67, s67, 0xff
  s_cbranch_scc1 L_h2
L_poll_7:
  buffer_load_dwordx4 v[20:23], v18, s[40:43], s66 offen sc1
  buffer_load_dwordx4 v[24:27], v18, s[40:43], s66 offen offset:1024 sc1
  s_sub_u32 s65, s65, 1
  s_cbranch_scc1 L_fin
  s_waitcnt vmcnt(0)
  v_xor_b32 v19, s56, v20
  v_bitop3_b32 v19, v19, v21, s57 bitop3:0xf6
  v_bitop3_b32 v19, v19, v22, s58 bitop3:0xf6
  v_bitop3_b32 v19, v19, v23, s59 bitop3:0xf6
  v_bitop3_b32 v19, v19, v24, s56 bitop3:0xf6
  v_bitop3_b32 v19, v19, v25, s57 bitop3:0xf6
  v_bitop3_b32 v19, v19, v26, s58 bitop3:0xf6
  v_bitop3_b32 v19, v19, v27, s59 bitop3:0xf6
  v_and_b32 v19, 0xff, v19
  v_cmp_ne_u32 vcc, 0, v19
  s_cbranch_vccnz L_poll_7
L_h4:
  v_perm_b32 v64, v21, v20, s61
  v_perm_b32 v65, v23, v22, s61
  v_perm_b32 v66, v25, v24, s61
  v_perm_b32 v67, v27, v26, s61
  ds_write_b64 v17, v[64:65] offset:0
  ds_write_b64 v17, v[66:67] offset:512
  v_mov_b32 v16, 0
  v_mov_b32 v17, 1
  ds_write_b32 v16, v17 offset:1280
  s_setprio 0
  s_waitcnt vmcnt(0)
L_svc1:
  s_sub_u32 s66, s53, 24
  s_cmp_ge_u32 s66, 8
  s_cbranch_scc1 L_tl
  s_lshl3_add_u32 s75, s3, s66
  s_add_u32 s75, s75, 32
  s_mov_b32 s77, 3
  v_lshrrev_b32 v16, 2, v3
  v_lshl_add_u32 v16, v2, 4, v16
  v_mul_u32_u24 v16, 12288, v16
  v_and_b32 v17, 3, v3
  v_lshl_add_u32 v16, v17, 4, v16
  s_mul_i32 s66, s52, 786432
  s_lshl_b32 s67, s75, 6
  s_add_u32 s66, s66, s67
  s_mov_b32 s46, 3145728
  s_waitcnt lgkmcnt(0)
  s_mov_b64 s[44:45], s[24:25]
  s_mov_b64 s[48:49], s[22:23]
  buffer_load_dword v24, v10, s[48:51], 0 offen
  buffer_load_dwordx4 v[32:35], v16, s[44:47], s66 offen
  s_add_u32 s66, s66, 6144
  buffer_load_dwordx4 v[36:39], v16, s[44:47], s66 offen
  s_add_u32 s66, s66, 43008
  s_waitcnt vmcnt(1)
  buffer_load_dwordx4 v[40:43], v16, s[44:47], s66 offen
  s_add_u32 s66, s66, 6144
  s_waitcnt vmcnt(1)
  buffer_load_dwordx4 v[44:47], v16, s[44:47], s66 offen
  s_add_u32 s66, s66, 43008
  s_waitcnt vmcnt(1)
  buffer_load_dwordx4 v[48:51], v16, s[44:47], s66 offen
  s_add_u32 s66, s66, 6144
  s_waitcnt vmcnt(1)
  buffer_load_dwordx4 v[52:55], v16, s[44:47], s66 offen
  s_add_u32 s66, s66, 43008
  s_waitcnt vmcnt(1)
  buffer_load_dwordx4 v[56:59], v16, s[44:47], s66 offen
  s_add_u32 s66, s66, 6144
  s_waitcnt vmcnt(1)
  buffer_load_dwordx4 v[60:63], v16, s[44:47], s66 offen
  s_add_u32 s66, s66, 43008
  s_branch L_jobM
L_tl:
  s_mov_b32 s74, 0
  s_cmp_lt_u32 s53, 8
  s_cbranch_scc1 L_isW
  s_cmp_ge_u32 s53, 24
  s_cbranch_scc1 L_isW
  s_cmp_lt_u32 s53, 16
  s_cbranch_scc1 L_isZ
  s_cmp_eq_u32 s53, 23
  s_cbranch_scc1 L_T4
  s_mov_b32 s74, 2
  s_mul_i32 s73, s3, 7
  s_add_u32 s73, s73, s53
  s_sub_u32 s73, s73, 16
  s_branch L_T4
L_isZ:
  s_cmp_lt_u32 s53, 12
  s_cselect_b32 s74, 3, 0
  s_branch L_T4
L_isW:
  s_mov_b32 s74, 1
  s_and_b32 s72, s53, 15
  s_lshr_b32 s73, s72, 3
  s_lshl_b32 s66, s3, 1
  s_add_u32 s73, s73, s66
  s_and_b32 s72, s72, 7
L_T4:
L_tailprep:
  s_waitcnt vmcnt(0) lgkmcnt(0)
  s_cmp_lg_u32 s52, 1
  s_cbranch_scc1 L_warmed
  s_mov_b64 exec, 0
  s_branch L_pad0
L_warm_ret:
  s_mov_b64 exec, -1
L_warmed:
  v_mov_b32 v23, 0
  s_cmp_eq_u32 s74, 1
  s_cbranch_scc1 L_prepW
  v_lshrrev_b32 v58, 2, v1
  v_mul_u32_u24 v58, 3584, v58
  v_and_b32 v59, 3, v1
  v_lshl_add_u32 v58, v59, 7, v58
  s_sub_u32 s70, s53, 8
  s_lshl_b32 s70, s70, 1
  s_lshr_b32 s71, s52, 1
  s_add_u32 s70, s70, s71
  s_mul_i32 s70, s70, 57344
  s_mul_i32 s71, s3, 448
  s_andn2_b32 s71, s71, 127
  s_add_u32 s70, s70, s71
  v_add_u32 v58, s70, v58
  s_bitcmp1_b32 s52, 0
  s_cselect_b64 s[14:15], s[18:19], s[16:17]
  v_mul_u32_u24 v59, 1152, v1
  s_mul_i32 s75, s3, 73728
  s_add_u32 s75, s75, 393216
  s_cmp_lg_u32 s74, 0
  s_cbranch_scc1 L_np
L_lw_9:
  ds_read_b32 v19, v23 offset:1292
  s_waitcnt lgkmcnt(0)
  v_cmp_le_u32 vcc, 32, v19
  s_cbranch_vccnz L_lwok_10
  s_sleep 2
  s_sub_u32 s65, s65, 1
  s_cbranch_scc1 L_fin
  s_branch L_lw_9
L_lwok_10:
  s_branch L_P
L_np:
L_lw_11:
  ds_read_b32 v19, v23 offset:1280
  s_waitcnt lgkmcnt(0)
  v_cmp_eq_u32 vcc, 16, v19
  s_cbranch_vccnz L_lwok_12
  s_sleep 16
  s_sub_u32 s65, s65, 1
  s_cbranch_scc1 L_fin
  s_branch L_lw_11
L_lwok_12:
  s_cmp_eq_u32 s74, 3
  s_cbranch_scc1 L_prepZ
  v_and_b32 v11, 31, v1
  s_lshl_b32 s66, s52, 9
  v_lshl_add_u32 v11, v11, 4, s66
  v_lshrrev_b32 v16, 5, v1
  v_lshl_add_u32 v9, v16, 3, v11
  v_lshl_add_u32 v11, v16, 14, v11
  v_add_u32 v10, 0x1000, v11
  v_lshl_add_u32 v13, v1, 3, s66
  v_mul_u32_u24 v20, 74, v16
  v_add_u32 v20, s56, v20
  v_add_u32 v21, 37, v20
  v_lshrrev_b32 v16, 2, v1
  v_and_b32 v12, 3, v1
  v_lshl_add_u32 v12, v12, 7, s66
  v_lshl_add_u32 v12, v16, 11, v12
  s_mov_b64 s[48:49], s[4:5]
  s_mov_b32 s50, 1024
  s_mov_b32 s51, 0x20000
  v_lshrrev_b32 v17, 1, v9
  buffer_load_dword v24, v17, s[48:51], 0 offen
  s_mov_b32 s66, 20480
  s_mov_b32 s67, 24576
L_poll_13:
  buffer_load_dwordx2 v[32:33], v9, s[40:43], s66 offen sc1
  buffer_load_dwordx2 v[34:35], v9, s[40:43], s66 offen offset:2048 sc1
  buffer_load_dwordx2 v[36:37], v9, s[40:43], s67 offen sc1
  s_sub_u32 s65, s65, 1
  s_cbranch_scc1 L_fin
  s_waitcnt vmcnt(0)
  v_xor_b32 v19, v20, v32
  v_bitop3_b32 v19, v19, v33, v21 bitop3:0xf6
  v_bitop3_b32 v19, v19, v34, v20 bitop3:0xf6
  v_bitop3_b32 v19, v19, v35, v21 bitop3:0xf6
  v_bitop3_b32 v19, v19, v36, v20 bitop3:0xf6
  v_bitop3_b32 v19, v19, v37, v21 bitop3:0xf6
  v_and_b32 v19, 0xff, v19
  v_cmp_ne_u32 vcc, 0, v19
  s_cbranch_vccnz L_poll_13
  v_and_b32 v32, s62, v32
  v_and_b32 v33, s62, v33
  v_and_b32 v34, s62, v34
  v_and_b32 v35, s62, v35
  v_and_b32 v36, s62, v36
  v_and_b32 v37, s62, v37
  v_add_f32 v36, 1.0, v36
  v_add_f32 v37, 1.0, v37
  v_cvt_pk_bf16_f32 v19, v36, v37
  v_lshlrev_b32 v36, 16, v19
  v_and_b32 v37, s62, v19
  v_lshlrev_b32 v38, 16, v24
  v_and_b32 v39, s62, v24
  s_mov_b32 s69, 65536
  s_mov_b32 s70, 73728
  s_lshl_b32 s66, s52, 8
  v_lshl_add_u32 v14, v1, 5, s66
  v_and_b32 v15, 7, v3
  v_lshl_add_u32 v15, v2, 3, v15
  v_lshlrev_b32 v15, 2, v15
  v_add_u32 v15, 6144, v15
  v_lshlrev_b32 v16, 4, v3
  v_lshrrev_b32 v17, 1, v2
  v_lshl_add_u32 v16, v17, 8, v16
  s_lshl_b32 s66, s73, 11
  s_lshl_b32 s67, s52, 9
  s_add_u32 s66, s66, s67
  s_add_u32 s76, s66, 262144
  s_lshl_b32 s66, s52, 3
  v_mov_b32 v22, s66
  s_mov_b32 s78, 0
  s_mov_b32 s79, 0xffff
  v_and_b32 v26, 1, v2
  v_lshlrev_b32 v26, 5, v26
  v_lshrrev_b32 v27, 1, v2
  v_add_u32 v26, v26, v27
  v_lshrrev_b32 v27, 3, v3
  v_lshl_add_u32 v26, v27, 1, v26
  v_mul_u32_u24 v26, 7168, v26
  v_and_b32 v27, 3, v3
  v_lshl_add_u32 v26, v27, 4, v26
  s_mul_i32 s66, s52, 458752
  s_lshl_b32 s67, s73, 6
  s_add_u32 s66, s66, s67
  v_add_u32 v26, s66, v26
  v_mov_b32 v27, 0
  v_mov_b32 v40, s16
  v_mov_b32 v41, s17
  s_mov_b32 exec_lo, 0xf0f0f0f0
  s_mov_b32 exec_hi, 0xf0f0f0f0
  v_mov_b32 v40, s18
  v_mov_b32 v41, s19
  s_mov_b64 exec, -1
  v_lshl_add_u64 v[40:41], v[26:27], 0, v[40:41]
  s_mov_b32 s66, 28672
  s_mov_b32 s67, 0
  v_lshl_add_u64 v[42:43], v[40:41], 0, s[66:67]
  v_lshl_add_u64 v[44:45], v[42:43], 0, s[66:67]
  v_lshl_add_u64 v[46:47], v[44:45], 0, s[66:67]
  v_lshl_add_u64 v[48:49], v[46:47], 0, s[66:67]
  v_lshl_add_u64 v[50:51], v[48:49], 0, s[66:67]
  v_lshl_add_u64 v[52:53], v[50:51], 0, s[66:67]
  v_lshl_add_u64 v[54:55], v[52:53], 0, s[66:67]
L_lw_15:
  ds_read_b32 v19, v23 offset:1292
  s_waitcnt lgkmcnt(0)
  v_cmp_le_u32 vcc, 1, v19
  s_cbranch_vccnz L_lwok_16
  s_sleep 2
  s_sub_u32 s65, s65, 1
  s_cbranch_scc1 L_fin
  s_branch L_lw_15
L_lwok_16:
L_lw_17:
  ds_read_b32 v19, v23 offset:1292
  s_waitcnt lgkmcnt(0)
  v_cmp_le_u32 vcc, 2, v19
  s_cbranch_vccnz L_lwok_18
  s_sleep 1
  s_sub_u32 s65, s65, 1
  s_cbranch_scc1 L_fin
  s_branch L_lw_17
L_lwok_18:
  s_branch L_F
L_prepZ:
  s_lshl_b32 s73, s3, 2
  s_add_u32 s73, s73, s53
  s_sub_u32 s73, s73, 8
  s_lshl_b32 s73, s73, 2
  s_add_u32 s73, s73, s52
  s_lshr_b32 s66, s73, 5
  s_lshl_b32 s66, s66, 9
  s_and_b32 s67, s73, 15
  s_lshl_b32 s67, s67, 5
  s_add_u32 s66, s66, s67
  s_and_b32 s67, s73, 16
  s_add_u32 s72, s66, s67
  v_lshl_add_u32 v9, v2, 2, s72
  v_mul_u32_u24 v20, 37, v2
  v_add_u32 v20, s56, v20
  s_mov_b64 s[48:49], s[4:5]
  s_mov_b32 s50, 1024
  s_mov_b32 s51, 0x20000
  s_mov_b64 s[44:45], s[26:27]
  s_mov_b32 s46, 1024
  s_mov_b32 s47, 0x20000
  v_lshrrev_b32 v13, 1, v9
  buffer_load_ushort v24, v13, s[48:51], 0 offen
  s_mov_b32 s66, 20480
  s_mov_b32 s67, 26624
L_poll_19:
  buffer_load_dword v32, v9, s[40:43], s66 offen sc1
  buffer_load_dword v33, v9, s[40:43], s67 offen sc1
  s_sub_u32 s65, s65, 1
  s_cbranch_scc1 L_fin
  s_waitcnt vmcnt(0)
  v_xor_b32 v19, v20, v32
  v_bitop3_b32 v19, v19, v33, v20 bitop3:0xf6
  v_and_b32 v19, 0xff, v19
  v_cmp_ne_u32 vcc, 0, v19
  s_cbranch_vccnz L_poll_19
  v_and_b32 v32, s62, v32
  v_and_b32 v33, s62, v33
  v_lshlrev_b32 v24, 16, v24
  s_and_b32 s66, s72, 0x1ff
  s_lshr_b32 s66, s66, 1
  s_andn2_b32 s67, s72, 0x1ff
  s_add_u32 s66, s66, s67
  v_lshrrev_b32 v11, 1, v2
  v_lshl_add_u32 v11, v11, 8, s66
  v_and_b32 v10, 1, v2
  v_lshl_add_u32 v11, v10, 2, v11
  v_lshlrev_b32 v12, 11, v1
  s_mov_b32 s69, 65536
  s_lshl_b32 s70, s73, 4
  s_add_u32 s70, s70, 262144
  v_mov_b32 v68, 0
  v_mov_b32 v69, 0
  v_mov_b32 v70, 0
  v_mov_b32 v71, 0
  s_mov_b32 s78, -1
  s_mov_b32 s79, 0xffffff
L_lw_21:
  ds_read_b32 v19, v23 offset:1292
  s_waitcnt lgkmcnt(0)
  v_cmp_le_u32 vcc, 32, v19
  s_cbranch_vccnz L_lwok_22
  s_sleep 2
  s_sub_u32 s65, s65, 1
  s_cbranch_scc1 L_fin
  s_branch L_lw_21
L_lwok_22:
  s_branch L_Z
L_prepW:
  v_mul_u32_u24 v16, 1152, v2
  v_lshrrev_b32 v17, 1, v3
  v_mul_u32_u24 v17, 4608, v17
  v_add_u32 v17, v17, v16
  s_lshr_b32 s66, s52, 1
  s_lshl_b32 s66, s66, 6
  v_add_u32 v17, s66, v17
  v_lshl_add_u32 v16, v3, 4, v16
  s_lshl_b32 s66, s52, 8
  v_add_u32 v16, s66, v16
  v_add_u32 v15, 4608, v16
  s_mul_i32 s66, s73, 36864
  s_add_u32 s66, s66, 393216
  s_add_u32 s67, s66, 9216
  s_add_u32 s68, s66, 18432
  s_add_u32 s69, s66, 27648
  s_lshl_b32 s70, s52, 9
  s_add_u32 s70, s70, 2048
  v_lshrrev_b32 v18, 3, v3
  v_lshl_add_u32 v18, v18, 8, s70
  v_and_b32 v19, 1, v3
  v_lshl_add_u32 v18, v19, 7, v18
  v_bfe_u32 v19, v3, 1, 2
  v_lshl_add_u32 v18, v19, 2, v18
  v_lshlrev_b32 v14, 9, v2
  v_lshl_add_u32 v14, v3, 4, v14
  v_lshrrev_b32 v13, 1, v1
  v_mul_u32_u24 v13, 1152, v13
  v_and_b32 v12, 1, v1
  v_lshl_add_u32 v12, v12, 7, v13
  s_lshl_b32 s70, s52, 8
  v_add_u32 v12, s70, v12
  v_lshlrev_b32 v20, 2, v1
  s_lshl_b32 s70, s73, 11
  s_lshl_b32 s71, s72, 8
  s_add_u32 s70, s70, s71
  s_add_u32 s76, s70, 65536
L_lw_23:
  ds_read_b32 v19, v23 offset:1292
  s_waitcnt lgkmcnt(0)
  v_cmp_le_u32 vcc, 1, v19
  s_cbranch_vccnz L_lwok_24
  s_sleep 2
  s_sub_u32 s65, s65, 1
  s_cbranch_scc1 L_fin
  s_branch L_lw_23
L_lwok_24:
  s_branch L_W
L_tail_start:
L_vf0:
L_pad0:
  s_cbranch_execz L_pad1
  s_mov_b32 s44, 0
  s_mov_b32 s45, 0
  v_cmp_gt_f32 vcc, v93, v84
  s_cbranch_vccz L_vp0
  v_max_f32_dpp v93, v93, v93 row_ror:4 row_mask:0xf bank_mask:0xf
  s_nop 1
  v_max_f32_dpp v93, v93, v93 row_ror:8 row_mask:0xf bank_mask:0xf
  v_mov_b32 v92, v93
  s_nop 1
  v_permlane16_swap_b32 v93, v92
  v_max_f32 v93, v93, v92
  v_mov_b32 v92, v93
  s_nop 1
  v_permlane32_swap_b32 v93, v92
  v_max_f32 v93, v93, v92
  v_sub_f32 v92, v84, v93
  v_mul_f32 v92, s63, v92
  v_exp_f32 v94, v92
  v_mov_b32 v84, v93
  v_mul_f32 v85, s63, v93
  v_mul_f32 v86, v86, v94
  v_pk_mul_f32 v[32:33], v[32:33], v[94:95] op_sel_hi:[1,0]
  v_pk_mul_f32 v[34:35], v[34:35], v[94:95] op_sel_hi:[1,0]
  v_pk_mul_f32 v[36:37], v[36:37], v[94:95] op_sel_hi:[1,0]
L_pad1:
  s_cbranch_execz L_pad2
  v_pk_mul_f32 v[38:39], v[38:39], v[94:95] op_sel_hi:[1,0]
  v_pk_mul_f32 v[40:41], v[40:41], v[94:95] op_sel_hi:[1,0]
  v_pk_mul_f32 v[42:43], v[42:43], v[94:95] op_sel_hi:[1,0]
  v_pk_mul_f32 v[44:45], v[44:45], v[94:95] op_sel_hi:[1,0]
  v_pk_mul_f32 v[46:47], v[46:47], v[94:95] op_sel_hi:[1,0]
  v_pk_mul_f32 v[48:49], v[48:49], v[94:95] op_sel_hi:[1,0]
  v_pk_mul_f32 v[50:51], v[50:51], v[94:95] op_sel_hi:[1,0]
  v_pk_mul_f32 v[52:53], v[52:53], v[94:95] op_sel_hi:[1,0]
  v_pk_mul_f32 v[54:55], v[54:55], v[94:95] op_sel_hi:[1,0]
  v_pk_mul_f32 v[56:57], v[56:57], v[94:95] op_sel_hi:[1,0]
  v_pk_mul_f32 v[58:59], v[58:59], v[94:95] op_sel_hi:[1,0]
  v_pk_mul_f32 v[60:61], v[60:61], v[94:95] op_sel_hi:[1,0]
  v_pk_mul_f32 v[62:63], v[62:63], v[94:95] op_sel_hi:[1,0]
  s_branch L_vp0
L_last0:
  s_mov_b32 s9, 0
  s_branch L_last_
L_vf1:
  s_mov_b32 s44, 0
  s_mov_b32 s45, 0
L_pad2:
  s_cbranch_execz L_pad3
  v_cmp_gt_f32 vcc, v93, v84
  s_cbranch_vccz L_vp1
  v_max_f32_dpp v93, v93, v93 row_ror:4 row_mask:0xf bank_mask:0xf
  s_nop 1
  v_max_f32_dpp v93, v93, v93 row_ror:8 row_mask:0xf bank_mask:0xf
  v_mov_b32 v92, v93
  s_nop 1
  v_permlane16_swap_b32 v93, v92
  v_max_f32 v93, v93, v92
  v_mov_b32 v92, v93
  s_nop 1
  v_permlane32_swap_b32 v93, v92
  v_max_f32 v93, v93, v92
  v_sub_f32 v92, v84, v93
  v_mul_f32 v92, s63, v92
  v_exp_f32 v94, v92
  v_mov_b32 v84, v93
  v_mul_f32 v85, s63, v93
  v_mul_f32 v86, v86, v94
  v_pk_mul_f32 v[32:33], v[32:33], v[94:95] op_sel_hi:[1,0]
  v_pk_mul_f32 v[34:35], v[34:35], v[94:95] op_sel_hi:[1,0]
  v_pk_mul_f32 v[36:37], v[36:37], v[94:95] op_sel_hi:[1,0]
  v_pk_mul_f32 v[38:39], v[38:39], v[94:95] op_sel_hi:[1,0]
L_pad3:
  s_cbranch_execz L_pad4
  v_pk_mul_f32 v[40:41], v[40:41], v[94:95] op_sel_hi:[1,0]
  v_pk_mul_f32 v[42:43], v[42:43], v[94:95] op_sel_hi:[1,0]
  v_pk_mul_f32 v[44:45], v[44:45], v[94:95] op_sel_hi:[1,0]
  v_pk_mul_f32 v[46:47], v[46:47], v[94:95] op_sel_hi:[1,0]
  v_pk_mul_f32 v[48:49], v[48:49], v[94:95] op_sel_hi:[1,0]
  v_pk_mul_f32 v[50:51], v[50:51], v[94:95] op_sel_hi:[1,0]
  v_pk_mul_f32 v[52:53], v[52:53], v[94:95] op_sel_hi:[1,0]
  v_pk_mul_f32 v[54:55], v[54:55], v[94:95] op_sel_hi:[1,0]
  v_pk_mul_f32 v[56:57], v[56:57], v[94:95] op_sel_hi:[1,0]
  v_pk_mul_f32 v[58:59], v[58:59], v[94:95] op_sel_hi:[1,0]
  v_pk_mul_f32 v[60:61], v[60:61], v[94:95] op_sel_hi:[1,0]
  v_pk_mul_f32 v[62:63], v[62:63], v[94:95] op_sel_hi:[1,0]
  s_branch L_vp1
L_last1:
  s_mov_b32 s9, 32
  s_branch L_last_
L_vf2:
  s_mov_b32 s44, 0
  s_mov_b32 s45, 0
  v_cmp_gt_f32 vcc, v93, v84
L_pad4:
  s_cbranch_execz L_pad5
  s_cbranch_vccz L_vp2
  v_max_f32_dpp v93, v93, v93 row_ror:4 row_mask:0xf bank_mask:0xf
  s_nop 1
  v_max_f32_dpp v93, v93, v93 row_ror:8 row_mask:0xf bank_mask:0xf
  v_mov_b32 v92, v93
  s_nop 1
  v_permlane16_swap_b32 v93, v92
  v_max_f32 v93, v93, v92
  v_mov_b32 v92, v93
  s_nop 1
  v_permlane32_swap_b32 v93, v92
  v_max_f32 v93, v93, v92
  v_sub_f32 v92, v84, v93
  v_mul_f32 v92, s63, v92
  v_exp_f32 v94, v92
  v_mov_b32 v84, v93
  v_mul_f32 v85, s63, v93
  v_mul_f32 v86, v86, v94
  v_pk_mul_f32 v[32:33], v[32:33], v[94:95] op_sel_hi:[1,0]
  v_pk_mul_f32 v[34:35], v[34:35], v[94:95] op_sel_hi:[1,0]
  v_pk_mul_f32 v[36:37], v[36:37], v[94:95] op_sel_hi:[1,0]
  v_pk_mul_f32 v[38:39], v[38:39], v[94:95] op_sel_hi:[1,0]
  v_pk_mul_f32 v[40:41], v[40:41], v[94:95] op_sel_hi:[1,0]
L_pad5:
  s_cbranch_execz L_pad6
  v_pk_mul_f32 v[42:43], v[42:43], v[94:95] op_sel_hi:[1,0]
  v_pk_mul_f32 v[44:45], v[44:45], v[94:95] op_sel_hi:[1,0]
  v_pk_mul_f32 v[46:47], v[46:47], v[94:95] op_sel_hi:[1,0]
  v_pk_mul_f32 v[48:49], v[48:49], v[94:95] op_sel_hi:[1,0]
  v_pk_mul_f32 v[50:51], v[50:51], v[94:95] op_sel_hi:[1,0]
  v_pk_mul_f32 v[52:53], v[52:53], v[94:95] op_sel_hi:[1,0]
  v_pk_mul_f32 v[54:55], v[54:55], v[94:95] op_sel_hi:[1,0]
  v_pk_mul_f32 v[56:57], v[56:57], v[94:95] op_sel_hi:[1,0]
  v_pk_mul_f32 v[58:59], v[58:59], v[94:95] op_sel_hi:[1,0]
  v_pk_mul_f32 v[60:61], v[60:61], v[94:95] op_sel_hi:[1,0]
  v_pk_mul_f32 v[62:63], v[62:63], v[94:95] op_sel_hi:[1,0]
  s_branch L_vp2
L_last2:
  s_mov_b32 s9, 64
  s_branch L_last_
L_vf3:
  s_mov_b32 s44, 0
  s_mov_b32 s45, 0
  v_cmp_gt_f32 vcc, v93, v84
  s_cbranch_vccz L_vp3
L_pad6:
  s_cbranch_execz L_pad7
  v_max_f32_dpp v93, v93, v93 row_ror:4 row_mask:0xf bank_mask:0xf
  s_nop 1
  v_max_f32_dpp v93, v93, v93 row_ror:8 row_mask:0xf bank_mask:0xf
  v_mov_b32 v92, v93
  s_nop 1
  v_permlane16_swap_b32 v93, v92
  v_max_f32 v93, v93, v92
  v_mov_b32 v92, v93
  s_nop 1
  v_permlane32_swap_b32 v93, v92
  v_max_f32 v93, v93, v92
  v_sub_f32 v92, v84, v93
  v_mul_f32 v92, s63, v92
  v_exp_f32 v94, v92
  v_mov_b32 v84, v93
  v_mul_f32 v85, s63, v93
  v_mul_f32 v86, v86, v94
  v_pk_mul_f32 v[32:33], v[32:33], v[94:95] op_sel_hi:[1,0]
  v_pk_mul_f32 v[34:35], v[34:35], v[94:95] op_sel_hi:[1,0]
  v_pk_mul_f32 v[36:37], v[36:37], v[94:95] op_sel_hi:[1,0]
  v_pk_mul_f32 v[38:39], v[38:39], v[94:95] op_sel_hi:[1,0]
  v_pk_mul_f32 v[40:41], v[40:41], v[94:95] op_sel_hi:[1,0]
  v_pk_mul_f32 v[42:43], v[42:43], v[94:95] op_sel_hi:[1,0]
L_pad7:
  s_cbranch_execz L_pad8
  v_pk_mul_f32 v[44:45], v[44:45], v[94:95] op_sel_hi:[1,0]
  v_pk_mul_f32 v[46:47], v[46:47], v[94:95] op_sel_hi:[1,0]
  v_pk_mul_f32 v[48:49], v[48:49], v[94:95] op_sel_hi:[1,0]
  v_pk_mul_f32 v[50:51], v[50:51], v[94:95] op_sel_hi:[1,0]
  v_pk_mul_f32 v[52:53], v[52:53], v[94:95] op_sel_hi:[1,0]
  v_pk_mul_f32 v[54:55], v[54:55], v[94:95] op_sel_hi:[1,0]
  v_pk_mul_f32 v[56:57], v[56:57], v[94:95] op_sel_hi:[1,0]
  v_pk_mul_f32 v[58:59], v[58:59], v[94:95] op_sel_hi:[1,0]
  v_pk_mul_f32 v[60:61], v[60:61], v[94:95] op_sel_hi:[1,0]
  v_pk_mul_f32 v[62:63], v[62:63], v[94:95] op_sel_hi:[1,0]
  s_branch L_vp3
L_last3:
  s_mov_b32 s9, 96
  s_branch L_last_
L_nb:
  s_cmp_lg_u32 s51, 0
  s_cbranch_scc1 L_nbv
  s_mov_b32 s24, 1
  s_cmp_eq_u32 s47, 3
  s_cbranch_scc1 L_decw
L_swv:
  s_mov_b32 s51, 1
  s_add_u32 s50, s50, 8
L_pad8:
  s_cbranch_execz L_pad9
  s_mov_b32 s72, s74
  s_cmp_eq_u32 s47, 0
  s_cbranch_scc1 L_rhv
  s_mov_b32 s47, 0
  s_mov_b32 s72, s14
  s_mov_b32 s73, s15
  s_mov_b32 s49, s7
  s_cmp_lt_u32 s52, 6
  s_cbranch_scc1 L_hw
  ds_write_b32 v0, v3 offset:1280
  s_branch L_rhv
L_hw:
L_lw_3:
  ds_read_b32 v92, v0 offset:1280
  s_waitcnt lgkmcnt(0)
  v_cmp_eq_u32 vcc, 16, v92
  s_cbranch_vccnz L_lwok_4
  s_sleep 8
  s_sub_u32 s65, s65, 1
  s_cbranch_scc1 L_fin
  s_branch L_lw_3
L_lwok_4:
  s_branch L_rhv
L_nbv:
  s_cmp_eq_u32 s6, 0
  s_cbranch_scc1 L_nbn
  s_and_b32 s25, s22, 0xff
  s_lshr_b64 s[22:23], s[22:23], 8
  s_sub_u32 s6, s6, 8
  s_add_u32 s50, s50, 4
  s_mov_b32 s24, 2
L_pad9:
  s_cbranch_execz L_pad10
  s_branch L_dec
L_nbn:
  s_cmp_lt_u32 s52, 6
  s_cbranch_scc1 L_no
  s_mov_b32 s24, 0
L_decw:
  s_waitcnt lgkmcnt(0)
  s_mov_b32 s25, s78
L_dec:
  s_lshr_b32 s68, s25, 3
  s_and_b32 s67, s25, 7
  s_add_u32 s74, s68, 26
  s_mov_b32 s71, 1
  s_mul_i32 s66, s68, 2
  s_add_u32 s66, s66, 25
  s_cmp_lt_u32 s68, 1
  s_cselect_b32 s74, s66, s74
  s_cselect_b32 s71, 2, s71
  s_cmp_ge_u32 s74, 32
  s_cbranch_scc1 L_bad
  s_mov_b32 s72, s74
  s_add_u32 s73, s74, s71
  s_lshl_b32 s67, s67, 14
  s_add_u32 s49, s79, s67
  s_cmp_eq_u32 s24, 2
  s_cbranch_scc1 L_rhv
  s_mov_b32 s51, 0
  s_cmp_eq_u32 s24, 0
  s_cbranch_scc1 L_rhv
  s_mov_b32 s10, s25
  s_mov_b32 s11, 0
  s_lshl_b64 s[10:11], s[10:11], s6
  s_or_b64 s[22:23], s[22:23], s[10:11]
  s_add_u32 s6, s6, 8
L_pad10:
  s_cbranch_execz L_pad11
  s_add_u32 s8, s8, s71
  s_cmp_ge_u32 s25, 8
  s_cselect_b32 s47, 5, 1
  s_cmp_gt_u32 s8, 29
  s_cselect_b32 s47, 5, s47
  s_cmp_ge_u32 s6, 64
  s_cselect_b32 s47, 5, s47
L_rhv:
  s_cmp_eq_u32 s9, 0
  s_cbranch_scc1 L_hv0
  s_cmp_eq_u32 s9, 1
  s_cbranch_scc1 L_hv1
  s_cmp_eq_u32 s9, 2
  s_cbranch_scc1 L_hv2
  s_branch L_hv3
L_bad:
  s_cmp_eq_u32 s24, 1
  s_cbranch_scc1 L_swv
  s_mov_b64 exec, 1
  ds_add_u32 v0, v2 offset:1292
  s_mov_b64 exec, -1
L_no:
  s_add_u32 s50, s50, 12
  s_cmp_eq_u32 s9, 0
  s_cbranch_scc1 L_go0
  s_cmp_eq_u32 s9, 1
  s_cbranch_scc1 L_go1
  s_cmp_eq_u32 s9, 2
  s_cbranch_scc1 L_go2
  s_branch L_go3
L_last_:
  v_add_f32_dpp v86, v86, v86 row_ror:4 row_mask:0xf bank_mask:0xf
  s_nop 1
L_pad11:
  s_cbranch_execz L_pad12
  v_add_f32_dpp v86, v86, v86 row_ror:8 row_mask:0xf bank_mask:0xf
  v_and_b32 v20, 15, v1
  v_lshrrev_b32 v21, 4, v1
  s_and_b32 s68, s52, 3
  s_lshl_b32 s66, s68, 3
  v_lshl_add_u32 v30, v20, 5, s66
  s_lshl_b32 s66, s68, 11
  v_lshl_add_u32 v29, v20, 6, s66
  v_lshl_add_u32 v29, v21, 4, v29
  v_add_u32 v22, 8192, v6
  v_cmp_gt_u32 vcc, 4, v20
  s_nop 1
  v_cndmask_b32 v29, v22, v29, vcc
  s_and_b32 s66, s52, 1
  s_lshl_b32 s66, s66, 1
  v_lshrrev_b32 v21, 5, v1
  v_add_u32 v20, s66, v21
  v_lshlrev_b32 v8, 5, v20
  v_bfe_u32 v31, v1, 2, 3
  v_lshlrev_b32 v31, 8, v31
  v_lshl_add_u32 v31, v20, 6, v31
  v_and_b32 v20, 3, v1
L_pad12:
  s_cbranch_execz L_pad13
  v_lshl_add_u32 v31, v20, 4, v31
  v_and_b32 v9, 7, v1
  v_lshlrev_b32 v9, 3, v9
  v_lshl_add_u32 v9, v21, 6, v9
  v_mov_b32 v92, v86
  s_nop 1
  v_permlane16_swap_b32 v86, v92
  v_add_f32 v86, v86, v92
  v_mov_b32 v92, v86
  s_nop 1
  v_permlane32_swap_b32 v86, v92
  v_add_f32 v86, v86, v92
  v_mov_b32 v85, v86
  s_mov_b64 exec, 0xf
  ds_write_b64 v30, v[84:85] offset:1024
  s_mov_b64 exec, 1
  ds_add_u32 v0, v2 offset:1296
  s_mov_b64 exec, -1
  ds_read_b32 v28, v0 offset:1296
  ds_read_b128 v[20:23], v8 offset:1024
  ds_read_b128 v[24:27], v8 offset:1040
  v_mov_b32 v16, s56
  v_mov_b32 v17, s57
L_pad13:
  s_cbranch_execz L_pad14
  v_mov_b32 v18, s58
  v_mov_b32 v19, s59
  s_mov_b32 s24, 0
  s_cmp_ge_u32 s52, 6
  s_cbranch_scc1 L_l2
  s_waitcnt vmcnt(0)
  s_branch L_lpv
L_l2:
  s_waitcnt lgkmcnt(0)
  v_cmp_ne_u32 vcc, 4, v28
  s_cbranch_vccnz L_l3
  v_max3_f32 v10, v20, v22, v24
  v_max_f32 v10, v10, v26
  v_sub_f32 v20, v20, v10
  v_sub_f32 v22, v22, v10
  v_sub_f32 v24, v24, v10
  v_sub_f32 v26, v26, v10
  v_mul_f32 v20, s63, v20
  v_mul_f32 v22, s63, v22
  v_mul_f32 v24, s63, v24
  v_mul_f32 v26, s63, v26
  v_exp_f32 v20, v20
  v_exp_f32 v22, v22
  v_exp_f32 v24, v24
  v_exp_f32 v26, v26
  v_bfi_b32 v10, s64, v16, v10
  v_mul_f32 v11, v20, v21
  v_fmac_f32 v11, v22, v23
  v_fmac_f32 v11, v24, v25
  v_fmac_f32 v11, v26, v27
L_pad14:
  s_cbranch_execz L_pad15
  s_mov_b32 exec_lo, 0xff
  s_mov_b32 exec_hi, 0xff
  v_bfi_b32 v11, s64, v17, v11
  buffer_store_dwordx2 v[10:11], v9, s[40:43], s75 offen offset:1024 sc1
  s_mov_b64 exec, -1
  s_mov_b32 s24, 1
  s_waitcnt vmcnt(1)
  s_branch L_lpv
L_l3:
  s_waitcnt vmcnt(0)
L_lpv:
  s_set_gpr_idx_on s9, gpr_idx(SRC0,SRC1)
  s_nop 0
  v_perm_b32 v68, v132, v128, s60
  v_perm_b32 v69, v140, v136, s60
  v_perm_b32 v70, v148, v144, s60
  v_perm_b32 v71, v156, v152, s60
  v_perm_b32 v72, v132, v128, s61
  v_perm_b32 v73, v140, v136, s61
  v_perm_b32 v74, v148, v144, s61
  v_perm_b32 v75, v156, v152, s61
L_pad15:
  s_cbranch_execz L_pad16
  s_set_gpr_idx_off
  v_mfma_f32_16x16x32_bf16 v[32:35], v[68:71], v[64:67], v[32:35]
  v_mfma_f32_16x16x32_bf16 v[36:39], v[72:75], v[64:67], v[36:39]
  s_set_gpr_idx_on s9, gpr_idx(SRC0,SRC1)
  s_nop 0
  v_perm_b32 v76, v133, v129, s60
  v_perm_b32 v77, v141, v137, s60
  v_perm_b32 v78, v149, v145, s60
  v_perm_b32 v79, v157, v153, s60
  v_perm_b32 v80, v133, v129, s61
  v_perm_b32 v81, v141, v137, s61
  v_perm_b32 v82, v149, v145, s61
  v_perm_b32 v83, v157, v153, s61
  s_set_gpr_idx_off
  ds_write_b128 v29, v[32:35] offset:8192
  ds_write_b128 v29, v[36:39] offset:8448
  v_mfma_f32_16x16x32_bf16 v[40:43], v[76:79], v[64:67], v[40:43]
L_pad16:
  s_cbranch_execz L_pad17
  v_mfma_f32_16x16x32_bf16 v[44:47], v[80:83], v[64:67], v[44:47]
  s_set_gpr_idx_on s9, gpr_idx(SRC0,SRC1)
  s_nop 0
  v_perm_b32 v68, v134, v130, s60
  v_perm_b32 v69, v142, v138, s60
  v_perm_b32 v70, v150, v146, s60
  v_perm_b32 v71, v158, v154, s60
  v_perm_b32 v72, v134, v130, s61
  v_perm_b32 v73, v142, v138, s61
  v_perm_b32 v74, v150, v146, s61
  v_perm_b32 v75, v158, v154, s61
  s_set_gpr_idx_off
  ds_write_b128 v29, v[40:43] offset:8704
  ds_write_b128 v29, v[44:47] offset:8960
  v_mfma_f32_16x16x32_bf16 v[48:51], v[68:71], v[64:67], v[48:51]
  v_mfma_f32_16x16x32_bf16 v[52:55], v[72:75], v[64:67], v[52:55]
  s_set_gpr_idx_on s9, gpr_idx(SRC0,SRC1)
L_pad17:
  s_cbranch_execz L_pad18
  v_perm_b32 v76, v135, v131, s60
  v_perm_b32 v77, v143, v139, s60
  v_perm_b32 v78, v151, v147, s60
  v_perm_b32 v79, v159, v155, s60
  v_perm_b32 v80, v135, v131, s61
  v_perm_b32 v81, v143, v139, s61
  v_perm_b32 v82, v151, v147, s61
  v_perm_b32 v83, v159, v155, s61
  s_set_gpr_idx_off
  ds_write_b128 v29, v[48:51] offset:9216
  ds_write_b128 v29, v[52:55] offset:9472
  v_mfma_f32_16x16x32_bf16 v[56:59], v[76:79], v[64:67], v[56:59]
  v_mfma_f32_16x16x32_bf16 v[60:63], v[80:83], v[64:67], v[60:63]
  s_nop 6
  ds_write_b128 v29, v[56:59] offset:9728
  ds_write_b128 v29, v[60:63] offset:9984
  s_mov_b64 exec, 1
L_pad18:
  s_cbranch_execz L_pad19
  ds_add_u32 v0, v2 offset:1288
  s_mov_b64 exec, -1
  s_cmp_lg_u32 s24, 0
  s_cbranch_scc1 L_mrg
  s_cmp_lt_u32 s52, 6
  s_cbranch_scc1 L_hdone
L_mw:
  ds_read_b32 v28, v0 offset:1296
  ds_read_b128 v[20:23], v8 offset:1024
  ds_read_b128 v[24:27], v8 offset:1040
  s_sub_u32 s65, s65, 1
  s_cbranch_scc1 L_fin
  s_waitcnt lgkmcnt(0)
  v_cmp_ne_u32 vcc, 4, v28
  s_cbranch_vccnz L_mw
  v_max3_f32 v10, v20, v22, v24
  v_max_f32 v10, v10, v26
  v_sub_f32 v20, v20, v10
  v_sub_f32 v22, v22, v10
  v_sub_f32 v24, v24, v10
  v_sub_f32 v26, v26, v10
  v_mul_f32 v20, s63, v20
  v_mul_f32 v22, s63, v22
  v_mul_f32 v24, s63, v24
  v_mul_f32 v26, s63, v26
  v_exp_f32 v20, v20
  v_exp_f32 v22, v22
L_pad19:
  s_cbranch_execz L_pad20
  v_exp_f32 v24, v24
  v_exp_f32 v26, v26
  v_bfi_b32 v10, s64, v16, v10
  v_mul_f32 v11, v20, v21
  v_fmac_f32 v11, v22, v23
  v_fmac_f32 v11, v24, v25
  v_fmac_f32 v11, v26, v27
  s_mov_b32 exec_lo, 0xff
  s_mov_b32 exec_hi, 0xff
  v_bfi_b32 v11, s64, v17, v11
  buffer_store_dwordx2 v[10:11], v9, s[40:43], s75 offen offset:1024 sc1
  s_mov_b64 exec, -1
L_mrg:
  ds_read_b32 v28, v0 offset:1288
  ds_read_b128 v[96:99], v31 offset:8192
  ds_read_b128 v[100:103], v31 offset:10240
  ds_read_b128 v[104:107], v31 offset:12288
  ds_read_b128 v[108:111], v31 offset:14336
  s_sub_u32 s65, s65, 1
  s_cbranch_scc1 L_fin
  s_waitcnt lgkmcnt(3)
  v_cmp_ne_u32 vcc, 8, v28
L_pad20:
  s_cbranch_execz L_pad21
  s_cbranch_vccnz L_mrg
  v_pk_mul_f32 v[66:67], v[96:97], v[20:21] op_sel_hi:[1,0]
  v_pk_mul_f32 v[68:69], v[98:99], v[20:21] op_sel_hi:[1,0]
  s_waitcnt lgkmcnt(2)
  v_pk_fma_f32 v[66:67], v[100:101], v[22:23], v[66:67] op_sel_hi:[1,0,1]
  v_pk_fma_f32 v[68:69], v[102:103], v[22:23], v[68:69] op_sel_hi:[1,0,1]
  s_waitcnt lgkmcnt(1)
  v_pk_fma_f32 v[66:67], v[104:105], v[24:25], v[66:67] op_sel_hi:[1,0,1]
  v_pk_fma_f32 v[68:69], v[106:107], v[24:25], v[68:69] op_sel_hi:[1,0,1]
  s_waitcnt lgkmcnt(0)
  v_pk_fma_f32 v[66:67], v[108:109], v[26:27], v[66:67] op_sel_hi:[1,0,1]
  v_pk_fma_f32 v[68:69], v[110:111], v[26:27], v[68:69] op_sel_hi:[1,0,1]
  v_bfi_b32 v80, s64, v16, v66
  v_bfi_b32 v81, s64, v17, v67
  v_bfi_b32 v82, s64, v18, v68
  v_bfi_b32 v83, s64, v19, v69
  buffer_store_dwordx4 v[80:83], v6, s[40:43], s75 offen sc1
  s_mov_b64 exec, 1
L_pad21:
  s_cbranch_execz L_pad22
  ds_add_u32 v0, v3 offset:1292
  s_mov_b64 exec, -1
  s_branch L_hd2
L_hdone:
  v_lshlrev_b32 v97, 7, v1
  s_mov_b64 exec, 0x1ff
  buffer_load_dword v20, v97, s[40:43], s75 offen
  s_mov_b64 exec, -1
L_hd2:
  s_branch L_fin
L_W:
L_lw_25:
  ds_read_b32 v19, v23 offset:1292
  s_waitcnt lgkmcnt(0)
  v_cmp_le_u32 vcc, 2, v19
  s_cbranch_vccnz L_lwok_26
  s_sleep 1
  s_sub_u32 s65, s65, 1
  s_cbranch_scc1 L_fin
  s_branch L_lw_25
L_lwok_26:
  s_mov_b64 s[44:45], s[12:13]
  s_mov_b32 s46, 4194304
  s_mov_b32 s47, 0x20000
  v_lshlrev_b32 v26, 13, v2
  v_lshrrev_b32 v27, 3, v3
  v_lshl_add_u32 v26, v27, 11, v26
  v_and_b32 v27, 7, v3
L_pad22:
  s_cbranch_execz L_pad23
  v_lshl_add_u32 v26, v27, 4, v26
  s_lshl_b32 s70, s73, 18
  s_lshr_b32 s71, s52, 1
  s_lshl_b32 s71, s71, 17
  s_add_u32 s70, s70, s71
  s_and_b32 s71, s52, 1
  s_lshl_b32 s71, s71, 12
  s_add_u32 s70, s70, s71
  s_lshl_b32 s71, s72, 7
  s_add_u32 s70, s70, s71
  buffer_load_dwordx4 v[128:131], v26, s[44:47], s70 offen nt
  buffer_load_dwordx4 v[144:147], v26, s[44:47], s70 offen offset:1024 nt
  s_add_u32 s70, s70, 0x8000
  buffer_load_dwordx4 v[132:135], v26, s[44:47], s70 offen nt
  buffer_load_dwordx4 v[148:151], v26, s[44:47], s70 offen offset:1024 nt
  s_add_u32 s70, s70, 0x8000
  buffer_load_dwordx4 v[136:139], v26, s[44:47], s70 offen nt
  buffer_load_dwordx4 v[152:155], v26, s[44:47], s70 offen offset:1024 nt
  s_add_u32 s70, s70, 0x8000
  buffer_load_dwordx4 v[140:143], v26, s[44:47], s70 offen nt
L_pad23:
  s_cbranch_execz L_pad24
  buffer_load_dwordx4 v[156:159], v26, s[44:47], s70 offen offset:1024 nt
  s_add_u32 s70, s70, 0x8000
  s_waitcnt vmcnt(0)
  v_perm_b32 v160, v132, v128, s60
  v_perm_b32 v161, v140, v136, s60
  v_perm_b32 v162, v148, v144, s60
  v_perm_b32 v163, v156, v152, s60
  v_perm_b32 v164, v132, v128, s61
  v_perm_b32 v165, v140, v136, s61
  v_perm_b32 v166, v148, v144, s61
  v_perm_b32 v167, v156, v152, s61
  v_perm_b32 v168, v133, v129, s60
  v_perm_b32 v169, v141, v137, s60
  v_perm_b32 v170, v149, v145, s60
  v_perm_b32 v171, v157, v153, s60
  v_perm_b32 v172, v133, v129, s61
L_pad24:
  s_cbranch_execz L_pad25
  v_perm_b32 v173, v141, v137, s61
  v_perm_b32 v174, v149, v145, s61
  v_perm_b32 v175, v157, v153, s61
  v_perm_b32 v176, v134, v130, s60
  v_perm_b32 v177, v142, v138, s60
  v_perm_b32 v178, v150, v146, s60
  v_perm_b32 v179, v158, v154, s60
  v_perm_b32 v180, v134, v130, s61
  v_perm_b32 v181, v142, v138, s61
  v_perm_b32 v182, v150, v146, s61
  v_perm_b32 v183, v158, v154, s61
  v_perm_b32 v184, v135, v131, s60
  v_perm_b32 v185, v143, v139, s60
  v_perm_b32 v186, v151, v147, s60
  v_perm_b32 v187, v159, v155, s60
L_pad25:
  s_cbranch_execz L_pad26
  v_perm_b32 v188, v135, v131, s61
  v_perm_b32 v189, v143, v139, s61
  v_perm_b32 v190, v151, v147, s61
  v_perm_b32 v191, v159, v155, s61
L_lw_27:
  ds_read_b32 v19, v23 offset:1292
  s_waitcnt lgkmcnt(0)
  v_cmp_le_u32 vcc, 32, v19
  s_cbranch_vccnz L_lwok_28
  s_sleep 0
  s_sub_u32 s65, s65, 1
  s_cbranch_scc1 L_fin
  s_branch L_lw_27
L_lwok_28:
L_Wpoll:
  buffer_load_dwordx4 v[24:27], v17, s[40:43], s66 offen offset:1024 sc1
  buffer_load_dwordx4 v[32:35], v16, s[40:43], s66 offen sc1
  buffer_load_dwordx4 v[36:39], v15, s[40:43], s66 offen sc1
  buffer_load_dwordx4 v[40:43], v16, s[40:43], s67 offen sc1
  buffer_load_dwordx4 v[44:47], v15, s[40:43], s67 offen sc1
  buffer_load_dwordx4 v[48:51], v16, s[40:43], s68 offen sc1
L_pad26:
  s_cbranch_execz L_pad27
  buffer_load_dwordx4 v[52:55], v15, s[40:43], s68 offen sc1
  buffer_load_dwordx4 v[56:59], v16, s[40:43], s69 offen sc1
  buffer_load_dwordx4 v[60:63], v15, s[40:43], s69 offen sc1
  s_sub_u32 s65, s65, 1
  s_cbranch_scc1 L_fin
  s_waitcnt vmcnt(0)
  v_xor_b32 v21, s56, v24
  v_bitop3_b32 v21, v21, v25, s57 bitop3:0xf6
  v_bitop3_b32 v21, v21, v32, s56 bitop3:0xf6
  v_bitop3_b32 v21, v21, v36, s56 bitop3:0xf6
  v_bitop3_b32 v21, v21, v40, s56 bitop3:0xf6
  v_bitop3_b32 v21, v21, v44, s56 bitop3:0xf6
  v_bitop3_b32 v21, v21, v48, s56 bitop3:0xf6
  v_bitop3_b32 v21, v21, v52, s56 bitop3:0xf6
  v_bitop3_b32 v21, v21, v56, s56 bitop3:0xf6
  v_bitop3_b32 v21, v21, v60, s56 bitop3:0xf6
  v_and_b32 v21, 0xff, v21
  v_cmp_ne_u32 vcc, 0, v21
L_pad27:
  s_cbranch_execz L_pad28
  s_cbranch_vccz L_ok_29
  s_mov_b64 exec, vcc
  s_branch L_Wpoll
L_ok_29:
  s_mov_b64 exec, -1
  v_and_b32 v28, s62, v24
  v_xor_b32 v21, s56, v26
  v_bitop3_b32 v21, v21, v27, s57 bitop3:0xf6
  v_max_f32_dpp v22, v28, v28 row_ror:8 row_mask:0xf bank_mask:0xf
  v_bitop3_b32 v21, v21, v33, s57 bitop3:0xf6
  v_bitop3_b32 v21, v21, v34, s58 bitop3:0xf6
  v_max_f32_dpp v22, v22, v22 row_ror:4 row_mask:0xf bank_mask:0xf
  v_bitop3_b32 v21, v21, v35, s59 bitop3:0xf6
  v_bitop3_b32 v21, v21, v37, s57 bitop3:0xf6
  v_max_f32_dpp v22, v22, v22 row_ror:2 row_mask:0xf bank_mask:0xf
  v_mov_b32 v29, v22
  v_bitop3_b32 v21, v21, v38, s58 bitop3:0xf6
  v_bitop3_b32 v21, v21, v39, s59 bitop3:0xf6
  v_permlane16_swap_b32 v22, v29
  v_max_f32 v22, v22, v29
  v_mov_b32 v29, v22
L_pad28:
  s_cbranch_execz L_pad29
  v_bitop3_b32 v21, v21, v41, s57 bitop3:0xf6
  v_bitop3_b32 v21, v21, v42, s58 bitop3:0xf6
  v_permlane32_swap_b32 v22, v29
  v_max_f32 v22, v22, v29
  v_sub_f32 v28, v28, v22
  v_mul_f32 v28, s63, v28
  v_exp_f32 v28, v28
  v_bitop3_b32 v21, v21, v43, s59 bitop3:0xf6
  v_mul_f32 v22, v28, v25
  v_bitop3_b32 v21, v21, v45, s57 bitop3:0xf6
  v_mov_b32_dpp v64, v28 row_newbcast:0 row_mask:0xf bank_mask:0xf
  v_mov_b32_dpp v66, v28 row_newbcast:2 row_mask:0xf bank_mask:0xf
  v_mov_b32_dpp v68, v28 row_newbcast:4 row_mask:0xf bank_mask:0xf
  v_mov_b32_dpp v70, v28 row_newbcast:6 row_mask:0xf bank_mask:0xf
  v_mov_b32_dpp v72, v28 row_newbcast:8 row_mask:0xf bank_mask:0xf
  v_mov_b32_dpp v74, v28 row_newbcast:10 row_mask:0xf bank_mask:0xf
  v_mov_b32_dpp v76, v28 row_newbcast:12 row_mask:0xf bank_mask:0xf
  v_mov_b32_dpp v78, v28 row_newbcast:14 row_mask:0xf bank_mask:0xf
L_pad29:
  s_cbranch_execz L_pad30
  v_add_f32_dpp v22, v22, v22 row_ror:8 row_mask:0xf bank_mask:0xf
  v_pk_mul_f32 v[100:101], v[32:33], v[64:65] op_sel_hi:[1,0]
  v_pk_mul_f32 v[102:103], v[34:35], v[64:65] op_sel_hi:[1,0]
  v_pk_mul_f32 v[104:105], v[36:37], v[66:67] op_sel_hi:[1,0]
  v_pk_mul_f32 v[106:107], v[38:39], v[66:67] op_sel_hi:[1,0]
  v_add_f32_dpp v22, v22, v22 row_ror:4 row_mask:0xf bank_mask:0xf
  v_pk_fma_f32 v[100:101], v[40:41], v[68:69], v[100:101] op_sel_hi:[1,0,1]
  v_pk_fma_f32 v[102:103], v[42:43], v[68:69], v[102:103] op_sel_hi:[1,0,1]
  v_add_f32_dpp v22, v22, v22 row_ror:2 row_mask:0xf bank_mask:0xf
  v_pk_fma_f32 v[104:105], v[44:45], v[70:71], v[104:105] op_sel_hi:[1,0,1]
  v_pk_fma_f32 v[106:107], v[46:47], v[70:71], v[106:107] op_sel_hi:[1,0,1]
  v_mov_b32 v29, v22
  v_pk_fma_f32 v[100:101], v[48:49], v[72:73], v[100:101] op_sel_hi:[1,0,1]
  v_pk_fma_f32 v[102:103], v[50:51], v[72:73], v[102:103] op_sel_hi:[1,0,1]
  v_permlane16_swap_b32 v22, v29
  v_add_f32 v22, v22, v29
  v_pk_fma_f32 v[104:105], v[52:53], v[74:75], v[104:105] op_sel_hi:[1,0,1]
L_pad30:
  s_cbranch_execz L_pad31
  v_pk_fma_f32 v[106:107], v[54:55], v[74:75], v[106:107] op_sel_hi:[1,0,1]
  v_mov_b32 v29, v22
  v_pk_fma_f32 v[100:101], v[56:57], v[76:77], v[100:101] op_sel_hi:[1,0,1]
  v_pk_fma_f32 v[102:103], v[58:59], v[76:77], v[102:103] op_sel_hi:[1,0,1]
  v_permlane32_swap_b32 v22, v29
  v_add_f32 v22, v22, v29
  v_pk_fma_f32 v[104:105], v[60:61], v[78:79], v[104:105] op_sel_hi:[1,0,1]
  v_pk_fma_f32 v[106:107], v[62:63], v[78:79], v[106:107] op_sel_hi:[1,0,1]
  v_pk_add_f32 v[100:101], v[100:101], v[104:105]
  v_pk_add_f32 v[102:103], v[102:103], v[106:107]
  v_rcp_f32 v22, v22
  v_bitop3_b32 v21, v21, v46, s58 bitop3:0xf6
  v_permlane32_swap_b32 v100, v102
  v_permlane32_swap_b32 v101, v103
  v_pk_add_f32 v[100:101], v[100:101], v[102:103]
  v_bitop3_b32 v21, v21, v47, s59 bitop3:0xf6
  v_bitop3_b32 v21, v21, v49, s57 bitop3:0xf6
  v_permlane16_swap_b32 v100, v101
  v_add_f32 v100, v100, v101
  v_mul_f32 v100, v100, v22
L_pad31:
  s_cbranch_execz L_pad32
  v_bitop3_b32 v21, v21, v50, s58 bitop3:0xf6
  v_bitop3_b32 v21, v21, v51, s59 bitop3:0xf6
  v_mov_b32_dpp v101, v100 row_shl:1 row_mask:0xf bank_mask:0xf bound_ctrl:0
  v_cvt_pk_bf16_f32 v28, v100, v101
  v_bitop3_b32 v21, v21, v53, s57 bitop3:0xf6
  v_bitop3_b32 v21, v21, v54, s58 bitop3:0xf6
  v_mov_b32_dpp v29, v28 row_shl:2 row_mask:0xf bank_mask:0xf bound_ctrl:0
  v_mov_b32_dpp v30, v28 row_shl:4 row_mask:0xf bank_mask:0xf bound_ctrl:0
  v_mov_b32_dpp v31, v28 row_shl:6 row_mask:0xf bank_mask:0xf bound_ctrl:0
  v_bitop3_b32 v21, v21, v55, s59 bitop3:0xf6
  v_bitop3_b32 v21, v21, v57, s57 bitop3:0xf6
  v_mfma_f32_16x16x32_bf16 v[68:71], v[28:31], v[160:163], 0
  v_bitop3_b32 v21, v21, v58, s58 bitop3:0xf6
  v_bitop3_b32 v21, v21, v59, s59 bitop3:0xf6
  v_mfma_f32_16x16x32_bf16 v[72:75], v[28:31], v[164:167], 0
L_pad32:
  s_cbranch_execz L_pad33
  v_bitop3_b32 v21, v21, v61, s57 bitop3:0xf6
  v_bitop3_b32 v21, v21, v62, s58 bitop3:0xf6
  v_mfma_f32_16x16x32_bf16 v[76:79], v[28:31], v[168:171], 0
  v_bitop3_b32 v21, v21, v63, s59 bitop3:0xf6
  v_mfma_f32_16x16x32_bf16 v[80:83], v[28:31], v[172:175], 0
  v_mfma_f32_16x16x32_bf16 v[84:87], v[28:31], v[176:179], 0
  v_and_b32 v21, 0xff, v21
  v_cmp_ne_u32 vcc, 0, v21
  v_mfma_f32_16x16x32_bf16 v[88:91], v[28:31], v[180:183], 0
  v_mfma_f32_16x16x32_bf16 v[92:95], v[28:31], v[184:187], 0
  v_mfma_f32_16x16x32_bf16 v[96:99], v[28:31], v[188:191], 0
  s_cbranch_vccnz L_Wpoll
  s_mov_b32 exec_lo, 0xff
  s_mov_b32 exec_hi, 0xff00
  ds_write2_b32 v18, v68, v72 offset0:0 offset1:4
  ds_write2_b32 v18, v76, v80 offset0:8 offset1:12
L_pad33:
  s_cbranch_execz L_pad34
  ds_write2_b32 v18, v84, v88 offset0:16 offset1:20
  s_nop 0
  ds_write2_b32 v18, v92, v96 offset0:24 offset1:28
  s_mov_b64 exec, -1
  s_waitcnt lgkmcnt(0)
  s_barrier
  s_cmp_ge_u32 s52, 1
  s_cbranch_scc1 L_fin
  ds_read_b128 v[32:35], v14 offset:2048
  ds_read_b128 v[36:39], v14 offset:2304
  s_waitcnt lgkmcnt(0)
  v_pk_add_f32 v[32:33], v[32:33], v[36:37]
  v_pk_add_f32 v[34:35], v[34:35], v[38:39]
  s_nop 1
  v_permlane32_swap_b32 v32, v34
  v_permlane32_swap_b32 v33, v35
  v_pk_add_f32 v[32:33], v[32:33], v[34:35]
  s_nop 1
  v_permlane16_swap_b32 v32, v33
  v_add_f32 v32, v32, v33
  v_bfi_b32 v32, s64, v8, v32
  buffer_store_dword v32, v20, s[40:43], s76 offen sc1
L_pad34:
  s_cbranch_execz L_pad35
  s_branch L_fin
L_F:
  s_mov_b64 s[44:45], s[20:21]
  s_mov_b32 s46, 1835008
  s_mov_b32 s47, 0x20000
  v_lshlrev_b32 v26, 13, v2
  v_lshl_add_u32 v26, v3, 4, v26
  v_add_u32 v27, 0x1000, v26
  s_lshl_b32 s66, s73, 15
  s_lshl_b32 s67, s52, 8
  s_add_u32 s66, s66, s67
  buffer_load_dwordx4 v[96:99], v26, s[44:47], s66 offen offset:0 nt
  buffer_load_dwordx4 v[100:103], v26, s[44:47], s66 offen offset:1024 nt
  buffer_load_dwordx4 v[104:107], v26, s[44:47], s66 offen offset:2048 nt
  buffer_load_dwordx4 v[108:111], v26, s[44:47], s66 offen offset:3072 nt
  buffer_load_dwordx4 v[112:115], v27, s[44:47], s66 offen offset:0 nt
  buffer_load_dwordx4 v[116:119], v27, s[44:47], s66 offen offset:1024 nt
  buffer_load_dwordx4 v[120:123], v27, s[44:47], s66 offen offset:2048 nt
  buffer_load_dwordx4 v[124:127], v27, s[44:47], s66 offen offset:3072 nt
L_lw_30:
L_pad35:
  s_cbranch_execz L_pad36
  ds_read_b32 v19, v23 offset:1292
  s_waitcnt lgkmcnt(0)
  v_cmp_le_u32 vcc, 32, v19
  s_cbranch_vccnz L_lwok_31
  s_sleep 1
  s_sub_u32 s65, s65, 1
  s_cbranch_scc1 L_fin
  s_branch L_lw_30
L_lwok_31:
  s_mov_b32 exec_hi, 0
L_mlg_32:
  buffer_load_dwordx2 v[60:61], v59, s[40:43], s75 offen offset:1024 sc1
  s_sub_u32 s65, s65, 1
  s_cbranch_scc1 L_fin
  s_waitcnt vmcnt(0)
  v_xor_b32 v19, s56, v60
  v_bitop3_b32 v19, v19, v61, s57 bitop3:0xf6
  v_and_b32 v19, 0xff, v19
  v_cmp_ne_u32 vcc, 0, v19
  s_bcnt1_i32_b32 s66, vcc_lo
  s_cmp_gt_u32 s66, 12
  s_cbranch_scc1 L_mlg_32
  s_mov_b64 exec, -1
  global_load_dword v60, v58, s[14:15]
  v_perm_b32 v224, v100, v96, s60
L_pad36:
  s_cbranch_execz L_pad37
  v_perm_b32 v225, v108, v104, s60
  v_perm_b32 v226, v116, v112, s60
  v_perm_b32 v227, v124, v120, s60
  v_perm_b32 v228, v100, v96, s61
  v_perm_b32 v229, v108, v104, s61
  v_perm_b32 v230, v116, v112, s61
  v_perm_b32 v231, v124, v120, s61
  v_perm_b32 v232, v101, v97, s60
  v_perm_b32 v233, v109, v105, s60
  v_perm_b32 v234, v117, v113, s60
  v_perm_b32 v235, v125, v121, s60
  v_perm_b32 v236, v101, v97, s61
  v_perm_b32 v237, v109, v105, s61
  v_perm_b32 v238, v117, v113, s61
  v_perm_b32 v239, v125, v121, s61
L_pad37:
  s_cbranch_execz L_pad38
  v_perm_b32 v240, v102, v98, s60
  v_perm_b32 v241, v110, v106, s60
  v_perm_b32 v242, v118, v114, s60
  v_perm_b32 v243, v126, v122, s60
  v_perm_b32 v244, v102, v98, s61
  v_perm_b32 v245, v110, v106, s61
  v_perm_b32 v246, v118, v114, s61
  v_perm_b32 v247, v126, v122, s61
  v_perm_b32 v248, v103, v99, s60
  v_perm_b32 v249, v111, v107, s60
  v_perm_b32 v250, v119, v115, s60
  v_perm_b32 v251, v127, v123, s60
  v_perm_b32 v252, v103, v99, s61
  v_perm_b32 v253, v111, v107, s61
  v_perm_b32 v254, v119, v115, s61
L_pad38:
  s_cbranch_execz L_pad39
  v_perm_b32 v255, v127, v123, s61
  s_waitcnt vmcnt(0)
  global_load_dwordx4 v[128:131], v[40:41], off offset:0 sc1
  global_load_dwordx4 v[132:135], v[40:41], off offset:3584 sc1
  global_load_dwordx4 v[160:163], v[42:43], off offset:0 sc1
  global_load_dwordx4 v[164:167], v[42:43], off offset:3584 sc1
  global_load_dwordx4 v[136:139], v[44:45], off offset:0 sc1
  global_load_dwordx4 v[140:143], v[44:45], off offset:3584 sc1
  global_load_dwordx4 v[168:171], v[46:47], off offset:0 sc1
  global_load_dwordx4 v[172:175], v[46:47], off offset:3584 sc1
  global_load_dwordx4 v[144:147], v[48:49], off offset:0 sc1
  global_load_dwordx4 v[148:151], v[48:49], off offset:3584 sc1
  global_load_dwordx4 v[176:179], v[50:51], off offset:0 sc1
  global_load_dwordx4 v[180:183], v[50:51], off offset:3584 sc1
  global_load_dwordx4 v[152:155], v[52:53], off offset:0 sc1
  global_load_dwordx4 v[156:159], v[52:53], off offset:3584 sc1
L_pad39:
  s_cbranch_execz L_pad40
  global_load_dwordx4 v[184:187], v[54:55], off offset:0 sc1
  global_load_dwordx4 v[188:191], v[54:55], off offset:3584 sc1
  buffer_load_dword v64, v12, s[40:43], s69 offen sc1
  s_waitcnt vmcnt(1)
  v_perm_b32 v192, v164, v160, s60
  v_perm_b32 v193, v172, v168, s60
  v_perm_b32 v194, v180, v176, s60
  v_perm_b32 v195, v188, v184, s60
  v_perm_b32 v196, v164, v160, s61
  v_perm_b32 v197, v172, v168, s61
  v_perm_b32 v198, v180, v176, s61
  v_perm_b32 v199, v188, v184, s61
  v_perm_b32 v200, v165, v161, s60
  v_perm_b32 v201, v173, v169, s60
  v_perm_b32 v202, v181, v177, s60
  v_perm_b32 v203, v189, v185, s60
L_pad40:
  s_cbranch_execz L_pad41
  v_perm_b32 v204, v165, v161, s61
  v_perm_b32 v205, v173, v169, s61
  v_perm_b32 v206, v181, v177, s61
  v_perm_b32 v207, v189, v185, s61
  v_perm_b32 v208, v166, v162, s60
  v_perm_b32 v209, v174, v170, s60
  v_perm_b32 v210, v182, v178, s60
  v_perm_b32 v211, v190, v186, s60
  v_perm_b32 v212, v166, v162, s61
  v_perm_b32 v213, v174, v170, s61
  v_perm_b32 v214, v182, v178, s61
  v_perm_b32 v215, v190, v186, s61
  v_perm_b32 v216, v167, v163, s60
  v_perm_b32 v217, v175, v171, s60
  v_perm_b32 v218, v183, v179, s60
L_pad41:
  s_cbranch_execz L_pad42
  v_perm_b32 v219, v191, v187, s60
  v_perm_b32 v220, v167, v163, s61
  v_perm_b32 v221, v175, v171, s61
  v_perm_b32 v222, v183, v179, s61
  v_perm_b32 v223, v191, v187, s61
  v_perm_b32 v160, v132, v128, s60
  v_perm_b32 v161, v140, v136, s60
  v_perm_b32 v162, v148, v144, s60
  v_perm_b32 v163, v156, v152, s60
  v_perm_b32 v164, v132, v128, s61
  v_perm_b32 v165, v140, v136, s61
  v_perm_b32 v166, v148, v144, s61
  v_perm_b32 v167, v156, v152, s61
  v_perm_b32 v168, v133, v129, s60
  v_perm_b32 v169, v141, v137, s60
L_pad42:
  s_cbranch_execz L_pad43
  v_perm_b32 v170, v149, v145, s60
  v_perm_b32 v171, v157, v153, s60
  v_perm_b32 v172, v133, v129, s61
  v_perm_b32 v173, v141, v137, s61
  v_perm_b32 v174, v149, v145, s61
  v_perm_b32 v175, v157, v153, s61
  v_perm_b32 v176, v134, v130, s60
  v_perm_b32 v177, v142, v138, s60
  v_perm_b32 v178, v150, v146, s60
  v_perm_b32 v179, v158, v154, s60
  v_perm_b32 v180, v134, v130, s61
  v_perm_b32 v181, v142, v138, s61
  v_perm_b32 v182, v150, v146, s61
  v_perm_b32 v183, v158, v154, s61
  v_perm_b32 v184, v135, v131, s60
L_pad43:
  s_cbranch_execz L_pad44
  v_perm_b32 v185, v143, v139, s60
  v_perm_b32 v186, v151, v147, s60
  v_perm_b32 v187, v159, v155, s60
  v_perm_b32 v188, v135, v131, s61
  v_perm_b32 v189, v143, v139, s61
  v_perm_b32 v190, v151, v147, s61
  v_perm_b32 v191, v159, v155, s61
  s_branch L_Fl2
L_Flight:
  buffer_load_dword v64, v12, s[40:43], s69 offen sc1
  s_sub_u32 s65, s65, 1
  s_cbranch_scc1 L_fin
L_Fl2:
  s_waitcnt vmcnt(0)
  v_xor_b32 v19, s56, v64
  v_and_b32 v19, 0xff, v19
  v_cmp_ne_u32 vcc, 0, v19
  s_cmp_eq_u64 vcc, exec
  s_cbranch_scc1 L_Flight
  s_mov_b64 exec, -1
L_Fpoll:
  buffer_load_dwordx4 v[96:99], v11, s[40:43], s69 offen offset:0 sc1
  buffer_load_dwordx4 v[100:103], v11, s[40:43], s69 offen offset:2048 sc1
L_pad44:
  s_cbranch_execz L_pad45
  buffer_load_dwordx4 v[104:107], v10, s[40:43], s69 offen offset:0 sc1
  buffer_load_dwordx4 v[108:111], v10, s[40:43], s69 offen offset:2048 sc1
  buffer_load_dwordx4 v[112:115], v11, s[40:43], s70 offen offset:0 sc1
  buffer_load_dwordx4 v[116:119], v11, s[40:43], s70 offen offset:2048 sc1
  buffer_load_dwordx4 v[120:123], v10, s[40:43], s70 offen offset:0 sc1
  buffer_load_dwordx4 v[124:127], v10, s[40:43], s70 offen offset:2048 sc1
  s_sub_u32 s65, s65, 1
  s_cbranch_scc1 L_fin
  s_waitcnt vmcnt(0)
  v_xor_b32 v19, s56, v96
  v_bitop3_b32 v19, v19, v100, s56 bitop3:0xf6
  v_bitop3_b32 v19, v19, v104, s56 bitop3:0xf6
  v_bitop3_b32 v19, v19, v108, s56 bitop3:0xf6
  v_bitop3_b32 v19, v19, v112, s56 bitop3:0xf6
  v_bitop3_b32 v19, v19, v116, s56 bitop3:0xf6
  v_bitop3_b32 v19, v19, v120, s56 bitop3:0xf6
  v_bitop3_b32 v19, v19, v124, s56 bitop3:0xf6
L_pad45:
  s_cbranch_execz L_pad46
  v_and_b32 v19, 0xff, v19
  v_cmp_ne_u32 vcc, 0, v19
  s_cbranch_vccz L_ok_33
  s_mov_b64 exec, vcc
  s_branch L_Fpoll
L_ok_33:
  s_mov_b64 exec, -1
  v_pk_add_f32 v[64:65], v[96:97], v[112:113]
  v_pk_add_f32 v[66:67], v[98:99], v[114:115]
  v_pk_add_f32 v[68:69], v[100:101], v[116:117]
  v_pk_add_f32 v[70:71], v[102:103], v[118:119]
  v_pk_add_f32 v[72:73], v[104:105], v[120:121]
  v_pk_add_f32 v[74:75], v[106:107], v[122:123]
  v_pk_add_f32 v[76:77], v[108:109], v[124:125]
  v_pk_add_f32 v[78:79], v[110:111], v[126:127]
  v_pk_add_f32 v[64:65], v[64:65], v[72:73]
  v_pk_add_f32 v[66:67], v[66:67], v[74:75]
  v_pk_add_f32 v[68:69], v[68:69], v[76:77]
  v_pk_add_f32 v[70:71], v[70:71], v[78:79]
L_pad46:
  s_cbranch_execz L_pad47
  v_pk_add_f32 v[68:69], v[64:65], v[68:69]
  v_pk_add_f32 v[70:71], v[66:67], v[70:71]
  v_xor_b32 v19, s57, v97
  v_bitop3_b32 v19, v19, v98, s58 bitop3:0xf6
  v_permlane32_swap_b32 v68, v70
  v_permlane32_swap_b32 v69, v71
  v_pk_add_f32 v[68:69], v[68:69], v[70:71]
  v_cvt_pk_bf16_f32 v70, v68, v69
  v_lshlrev_b32 v68, 16, v70
  v_and_b32 v69, s62, v70
  v_pk_mul_f32 v[68:69], v[68:69], v[32:33]
  v_cvt_pk_bf16_f32 v70, v68, v69
  v_lshlrev_b32 v68, 16, v70
  v_and_b32 v69, s62, v70
  v_pk_add_f32 v[68:69], v[68:69], v[38:39]
  v_cvt_pk_bf16_f32 v70, v68, v69
  v_lshlrev_b32 v68, 16, v70
  v_and_b32 v69, s62, v70
  v_readfirstlane_b32 s71, v68
  v_bitop3_b32 v19, v19, v99, s59 bitop3:0xf6
L_pad47:
  s_cbranch_execz L_pad48
  v_bitop3_b32 v19, v19, v101, s57 bitop3:0xf6
  v_subrev_f32 v70, s71, v68
  v_subrev_f32 v71, s71, v69
  v_add_f32 v72, v70, v71
  v_mul_f32 v73, v70, v70
  v_fmac_f32 v73, v71, v71
  v_bitop3_b32 v19, v19, v102, s58 bitop3:0xf6
  v_bitop3_b32 v19, v19, v103, s59 bitop3:0xf6
  v_add_f32_dpp v72, v72, v72 row_ror:8 row_mask:0xf bank_mask:0xf
  v_add_f32_dpp v73, v73, v73 row_ror:8 row_mask:0xf bank_mask:0xf
  v_bitop3_b32 v19, v19, v105, s57 bitop3:0xf6
  v_add_f32_dpp v72, v72, v72 row_ror:4 row_mask:0xf bank_mask:0xf
  v_add_f32_dpp v73, v73, v73 row_ror:4 row_mask:0xf bank_mask:0xf
  v_bitop3_b32 v19, v19, v106, s58 bitop3:0xf6
  v_add_f32_dpp v72, v72, v72 row_ror:2 row_mask:0xf bank_mask:0xf
  v_add_f32_dpp v73, v73, v73 row_ror:2 row_mask:0xf bank_mask:0xf
  v_bitop3_b32 v19, v19, v107, s59 bitop3:0xf6
  v_add_f32_dpp v72, v72, v72 row_ror:1 row_mask:0xf bank_mask:0xf
L_pad48:
  s_cbranch_execz L_pad49
  v_add_f32_dpp v73, v73, v73 row_ror:1 row_mask:0xf bank_mask:0xf
  v_bitop3_b32 v19, v19, v109, s57 bitop3:0xf6
  v_bitop3_b32 v19, v19, v110, s58 bitop3:0xf6
  v_permlane16_swap_b32 v72, v73
  v_add_f32 v72, v72, v73
  v_mov_b32 v73, v72
  v_bitop3_b32 v19, v19, v111, s59 bitop3:0xf6
  v_bitop3_b32 v19, v19, v113, s57 bitop3:0xf6
  v_permlane32_swap_b32 v72, v73
  v_add_f32 v72, v72, v73
  v_mov_b32 v73, v72
  v_bitop3_b32 v19, v19, v114, s58 bitop3:0xf6
  v_bitop3_b32 v19, v19, v115, s59 bitop3:0xf6
  v_permlane16_swap_b32 v72, v73
  v_mul_f32 v74, 0x3c000000, v72
  v_fma_f32 v73, -v74, v72, v73
  v_add_f32 v72, s71, v74
  ds_write_b64 v22, v[72:73] offset:1344
  v_bitop3_b32 v19, v19, v117, s57 bitop3:0xf6
L_pad49:
  s_cbranch_execz L_pad50
  v_bitop3_b32 v19, v19, v118, s58 bitop3:0xf6
  v_bitop3_b32 v19, v19, v119, s59 bitop3:0xf6
  v_bitop3_b32 v19, v19, v121, s57 bitop3:0xf6
  v_bitop3_b32 v19, v19, v122, s58 bitop3:0xf6
  v_bitop3_b32 v19, v19, v123, s59 bitop3:0xf6
  v_bitop3_b32 v19, v19, v125, s57 bitop3:0xf6
  v_bitop3_b32 v19, v19, v126, s58 bitop3:0xf6
  v_bitop3_b32 v19, v19, v127, s59 bitop3:0xf6
  v_and_b32 v19, 0xff, v19
  v_cmp_ne_u32 vcc, 0, v19
  s_cbranch_vccnz L_Fpoll
  s_waitcnt lgkmcnt(0)
  s_barrier
  ds_read_b128 v[72:75], v23 offset:1344
  ds_read_b128 v[76:79], v23 offset:1360
  s_cmp_lg_u32 s73, 0
  s_cbranch_scc1 L_nox1
  v_bfi_b32 v64, s64, v20, v68
L_pad50:
  s_cbranch_execz L_pad51
  v_bfi_b32 v65, s64, v21, v69
  s_mov_b32 s66, 98304
  buffer_store_dwordx2 v[64:65], v13, s[40:43], s66 offen sc1
L_nox1:
  s_waitcnt lgkmcnt(0)
  v_pk_add_f32 v[80:81], v[72:73], v[74:75]
  v_pk_add_f32 v[82:83], v[76:77], v[78:79]
  v_pk_add_f32 v[80:81], v[80:81], v[82:83]
  v_mul_f32 v80, 0x3e800000, v80
  v_sub_f32 v72, v72, v80
  v_sub_f32 v74, v74, v80
  v_sub_f32 v76, v76, v80
  v_sub_f32 v78, v78, v80
  v_mul_f32 v82, v72, v72
  v_mul_f32 v83, v74, v74
  v_fmac_f32 v82, v76, v76
  v_fmac_f32 v83, v78, v78
  v_mul_f32 v81, 0x3b000000, v81
  v_add_f32 v82, v82, v83
  v_fmac_f32 v81, 0x3e800000, v82
  v_cvt_pk_bf16_f32 v82, v80, v81
  v_lshlrev_b32 v80, 16, v82
L_pad51:
  s_cbranch_execz L_pad52
  v_and_b32 v81, s62, v82
  v_add_f32 v82, 0x3727c5ac, v81
  v_sub_f32 v68, v68, v80
  v_sub_f32 v69, v69, v80
  v_cvt_pk_bf16_f32 v82, v82, v82
  v_and_b32 v82, s62, v82
  v_sqrt_f32 v82, v82
  v_cvt_pk_bf16_f32 v70, v68, v69
  v_lshlrev_b32 v68, 16, v70
  v_and_b32 v69, s62, v70
  v_cvt_pk_bf16_f32 v82, v82, v82
  v_and_b32 v82, s62, v82
  v_rcp_f32 v82, v82
  s_nop 0
  v_pk_mul_f32 v[68:69], v[68:69], v[82:83] op_sel_hi:[1,0]
  v_cvt_pk_bf16_f32 v70, v68, v69
  v_lshlrev_b32 v68, 16, v70
  v_and_b32 v69, s62, v70
  v_pk_mul_f32 v[68:69], v[68:69], v[36:37]
  v_cvt_pk_bf16_f32 v70, v68, v69
  v_lshlrev_b32 v68, 16, v70
  v_and_b32 v69, s62, v70
L_pad52:
  s_cbranch_execz L_pad53
  v_pk_add_f32 v[68:69], v[68:69], v[34:35]
  v_cvt_pk_bf16_f32 v24, v68, v69
  s_nop 1
  v_mov_b32_dpp v25, v24 row_shl:4 row_mask:0xf bank_mask:0xf bound_ctrl:0
  v_mov_b32_dpp v26, v24 row_shl:8 row_mask:0xf bank_mask:0xf bound_ctrl:0
  v_mov_b32_dpp v27, v24 row_shl:12 row_mask:0xf bank_mask:0xf bound_ctrl:0
  s_nop 1
  v_mfma_f32_16x16x32_bf16 v[68:71], v[24:27], v[160:163], 0
  v_mov_b32_dpp v28, v24 row_shl:2 row_mask:0xf bank_mask:0xf bound_ctrl:0
  v_mfma_f32_16x16x32_bf16 v[72:75], v[24:27], v[164:167], 0
  v_mov_b32_dpp v29, v24 row_shl:6 row_mask:0xf bank_mask:0xf bound_ctrl:0
  v_mfma_f32_16x16x32_bf16 v[76:79], v[24:27], v[168:171], 0
  v_mov_b32_dpp v30, v24 row_shl:10 row_mask:0xf bank_mask:0xf bound_ctrl:0
  v_mfma_f32_16x16x32_bf16 v[80:83], v[24:27], v[172:175], 0
  v_mov_b32_dpp v31, v24 row_shl:14 row_mask:0xf bank_mask:0xf bound_ctrl:0
  v_mfma_f32_16x16x32_bf16 v[84:87], v[24:27], v[176:179], 0
L_pad53:
  s_cbranch_execz L_pad54
  v_mfma_f32_16x16x32_bf16 v[88:91], v[24:27], v[180:183], 0
  v_mfma_f32_16x16x32_bf16 v[92:95], v[24:27], v[184:187], 0
  v_mfma_f32_16x16x32_bf16 v[96:99], v[24:27], v[188:191], 0
  v_mfma_f32_16x16x32_bf16 v[68:71], v[28:31], v[192:195], v[68:71]
  v_mfma_f32_16x16x32_bf16 v[72:75], v[28:31], v[196:199], v[72:75]
  v_mfma_f32_16x16x32_bf16 v[76:79], v[28:31], v[200:203], v[76:79]
  v_mfma_f32_16x16x32_bf16 v[80:83], v[28:31], v[204:207], v[80:83]
  v_mfma_f32_16x16x32_bf16 v[84:87], v[28:31], v[208:211], v[84:87]
  v_mfma_f32_16x16x32_bf16 v[88:91], v[28:31], v[212:215], v[88:91]
  v_mfma_f32_16x16x32_bf16 v[92:95], v[28:31], v[216:219], v[92:95]
  v_mfma_f32_16x16x32_bf16 v[96:99], v[28:31], v[220:223], v[96:99]
L_pad54:
  s_cbranch_execz L_pad55
  v_add_f32_dpp v100, v69, v68 row_shl:8 row_mask:0xf bank_mask:0xf bound_ctrl:0
  v_add_f32_dpp v101, v73, v72 row_shl:8 row_mask:0xf bank_mask:0xf bound_ctrl:0
  v_add_f32_dpp v102, v77, v76 row_shl:8 row_mask:0xf bank_mask:0xf bound_ctrl:0
  v_add_f32_dpp v103, v81, v80 row_shl:8 row_mask:0xf bank_mask:0xf bound_ctrl:0
  v_add_f32_dpp v104, v85, v84 row_shl:8 row_mask:0xf bank_mask:0xf bound_ctrl:0
  v_add_f32_dpp v105, v89, v88 row_shl:8 row_mask:0xf bank_mask:0xf bound_ctrl:0
  v_add_f32_dpp v106, v93, v92 row_shl:8 row_mask:0xf bank_mask:0xf bound_ctrl:0
  v_add_f32_dpp v107, v97, v96 row_shl:8 row_mask:0xf bank_mask:0xf bound_ctrl:0
  s_mov_b64 exec, 0xff
  ds_write_b128 v14, v[100:103] offset:6144
  ds_write_b128 v14, v[104:107] offset:6160
  s_mov_b64 exec, -1
  s_waitcnt lgkmcnt(0)
  s_barrier
  ds_read2_b32 v[68:69], v15 offset0:0 offset1:32
  ds_read2_b32 v[70:71], v15 offset0:64 offset1:96
  ds_read2_b32 v[72:73], v15 offset0:128 offset1:160
L_pad55:
  s_cbranch_execz L_pad56
  ds_read2_b32 v[74:75], v15 offset0:192 offset1:224
  s_waitcnt lgkmcnt(0)
  v_pk_add_f32 v[68:69], v[68:69], v[70:71]
  v_pk_add_f32 v[72:73], v[72:73], v[74:75]
  v_pk_add_f32 v[68:69], v[68:69], v[72:73]
  v_cvt_pk_bf16_f32 v70, v68, v69
  v_lshlrev_b32 v68, 16, v70
  v_and_b32 v69, s62, v70
  v_mul_f32 v70, 0xbfb8aa3b, v68
  v_exp_f32 v70, v70
  s_nop 0
  v_add_f32 v70, 1.0, v70
  v_rcp_f32 v70, v70
  s_nop 0
  v_mul_f32 v68, v68, v70
  v_cvt_pk_bf16_f32 v68, v68, v68
  v_and_b32 v68, s62, v68
  v_mul_f32 v68, v68, v69
  s_nop 1
  v_mov_b32_dpp v69, v68 row_shl:1 row_mask:0xf bank_mask:0xf bound_ctrl:0
  v_cvt_pk_bf16_f32 v24, v68, v69
  s_nop 1
L_pad56:
  s_cbranch_execz L_pad57
  v_mov_b32_dpp v25, v24 row_shl:2 row_mask:0xf bank_mask:0xf bound_ctrl:0
  v_mov_b32_dpp v26, v24 row_shl:4 row_mask:0xf bank_mask:0xf bound_ctrl:0
  v_mov_b32_dpp v27, v24 row_shl:6 row_mask:0xf bank_mask:0xf bound_ctrl:0
  s_nop 1
  v_mfma_f32_16x16x32_bf16 v[68:71], v[24:27], v[224:227], 0
  v_mfma_f32_16x16x32_bf16 v[84:87], v[24:27], v[240:243], 0
  v_mfma_f32_16x16x32_bf16 v[72:75], v[24:27], v[228:231], 0
  v_mfma_f32_16x16x32_bf16 v[88:91], v[24:27], v[244:247], 0
  v_mfma_f32_16x16x32_bf16 v[76:79], v[24:27], v[232:235], 0
  v_mfma_f32_16x16x32_bf16 v[92:95], v[24:27], v[248:251], 0
  v_mfma_f32_16x16x32_bf16 v[80:83], v[24:27], v[236:239], 0
  v_mfma_f32_16x16x32_bf16 v[96:99], v[24:27], v[252:255], 0
  s_mov_b32 exec_lo, 0xffff
  s_mov_b32 exec_hi, 0xffff
  v_cndmask_b32 v100, v68, v84, s[78:79]
L_pad57:
  s_cbranch_execz L_pad58
  v_cndmask_b32 v101, v72, v88, s[78:79]
  s_nop 0
  v_cndmask_b32 v102, v76, v92, s[78:79]
  s_nop 0
  v_cndmask_b32 v103, v80, v96, s[78:79]
  v_bfi_b32 v100, s64, v4, v100
  v_bfi_b32 v101, s64, v5, v101
  v_bfi_b32 v102, s64, v6, v102
  v_bfi_b32 v103, s64, v7, v103
  buffer_store_dwordx4 v[100:103], v16, s[40:43], s76 offen sc1
  s_mov_b64 exec, -1
  s_branch L_fin
L_P:
  s_mov_b32 exec_hi, 0
L_mlg_34:
  buffer_load_dwordx2 v[60:61], v59, s[40:43], s75 offen offset:1024 sc1
  s_sub_u32 s65, s65, 1
  s_cbranch_scc1 L_fin
  s_waitcnt vmcnt(0)
  v_xor_b32 v19, s56, v60
  v_bitop3_b32 v19, v19, v61, s57 bitop3:0xf6
  v_and_b32 v19, 0xff, v19
L_pad58:
  s_cbranch_execz L_pad59
  v_cmp_ne_u32 vcc, 0, v19
  s_bcnt1_i32_b32 s66, vcc_lo
  s_cmp_gt_u32 s66, 12
  s_cbranch_scc1 L_mlg_34
  s_mov_b64 exec, -1
  global_load_dword v60, v58, s[14:15]
  s_branch L_fin
L_Z:
  s_mov_b32 exec_hi, 0
L_mlg_35:
  buffer_load_dwordx2 v[60:61], v59, s[40:43], s75 offen offset:1024 sc1
  s_sub_u32 s65, s65, 1
  s_cbranch_scc1 L_fin
  s_waitcnt vmcnt(0)
  v_xor_b32 v19, s56, v60
  v_bitop3_b32 v19, v19, v61, s57 bitop3:0xf6
  v_and_b32 v19, 0xff, v19
  v_cmp_ne_u32 vcc, 0, v19
  s_bcnt1_i32_b32 s66, vcc_lo
  s_cmp_gt_u32 s66, 12
  s_cbranch_scc1 L_mlg_35
  s_mov_b64 exec, -1
  global_load_dword v60, v58, s[14:15]
  s_mov_b32 s69, 98304
  s_mov_b64 exec, s[78:79]
  buffer_load_dword v35, v12, s[40:43], s70 offen sc1
L_pad59:
  s_cbranch_execz L_pad60
  s_mov_b64 exec, -1
L_poll_36:
  buffer_load_dword v34, v11, s[40:43], s69 offen sc1
  s_sub_u32 s65, s65, 1
  s_cbranch_scc1 L_fin
  s_waitcnt vmcnt(0)
  v_xor_b32 v19, v20, v34
  v_and_b32 v19, 0xff, v19
  v_cmp_ne_u32 vcc, 0, v19
  s_cbranch_vccnz L_poll_36
  s_mov_b64 exec, s[78:79]
L_poll_38:
  buffer_load_dwordx4 v[68:71], v12, s[40:43], s70 offen sc1
  s_sub_u32 s65, s65, 1
  s_cbranch_scc1 L_fin
  s_waitcnt vmcnt(0)
  v_xor_b32 v19, s56, v68
  v_bitop3_b32 v19, v19, v69, s57 bitop3:0xf6
  v_bitop3_b32 v19, v19, v70, s58 bitop3:0xf6
  v_bitop3_b32 v19, v19, v71, s59 bitop3:0xf6
  v_and_b32 v19, 0xff, v19
  v_cmp_ne_u32 vcc, 0, v19
  s_cbranch_vccz L_ok_39
  s_mov_b64 exec, vcc
  s_branch L_poll_38
L_ok_39:
  s_mov_b64 exec, -1
L_pad60:
  s_cbranch_execz L_pad61
  v_and_b32 v35, s62, v34
  v_permlane32_swap_b32 v68, v70
  v_permlane32_swap_b32 v69, v71
  v_pk_add_f32 v[68:69], v[68:69], v[70:71]
  s_nop 1
  v_permlane16_swap_b32 v68, v69
  v_add_f32 v68, v68, v69
  s_nop 1
  v_add_f32_dpp v68, v68, v68 row_ror:8 row_mask:0xf bank_mask:0xf
  s_nop 1
  v_add_f32_dpp v68, v68, v68 row_ror:4 row_mask:0xf bank_mask:0xf
  s_nop 1
  v_add_f32_dpp v68, v68, v68 row_ror:2 row_mask:0xf bank_mask:0xf
  s_nop 1
  v_add_f32_dpp v68, v68, v68 row_ror:1 row_mask:0xf bank_mask:0xf
  v_cvt_pk_bf16_f32 v68, v68, v68
  v_and_b32 v68, s62, v68
  v_mul_f32 v68, v68, v33
  v_cvt_pk_bf16_f32 v68, v68, v68
  v_and_b32 v68, s62, v68
  v_add_f32 v68, v68, v35
  v_cvt_pk_bf16_f32 v68, v68, v68
L_pad61:
  s_cbranch_execz L_pad62
  s_mov_b32 exec_lo, 0x00010001
  s_mov_b32 exec_hi, 0x00010001
  buffer_store_short v68, v13, s[44:47], 0 offen
L_zdone:
  s_endpgm
L_pad62:
  s_branch L_warm_ret
L_tail_end:
L_fin:
L_end:
  s_endpgm
L_last:
  s_endpgm
.section .rodata,"a"
.p2align 6
.amdhsa_kernel adaLN_cond__gqa_block_cached__swiglu_ffn__decode_kernel
  .amdhsa_next_free_vgpr 256
  .amdhsa_next_free_sgpr 102
  .amdhsa_accum_offset 256
  .amdhsa_group_segment_fixed_size 0
  .amdhsa_kernarg_size 112
  .amdhsa_user_sgpr_count 2
  .amdhsa_user_sgpr_kernarg_segment_ptr 1
  .amdhsa_system_sgpr_workgroup_id_x 1
  .amdhsa_float_denorm_mode_32 3
.end_amdhsa_kernel
```
